```python
import torch

def _softmax(x, axis=-1):
    return torch.softmax(x, dim=axis)
def _gelu(x):
    return torch.nn.functional.gelu(x, approximate="tanh")
def _silu(x):
    return torch.nn.functional.silu(x)
def _sigmoid(x):
    return torch.sigmoid(x)
def _layernorm(x, axis=-1, eps=1e-5):
    m = x.mean(dim=axis, keepdim=True)
    v = x.var(dim=axis, keepdim=True, unbiased=False)
    return (x - m) / torch.sqrt(v + eps)
def _scatter_add(tgt, idx, src, axis=0):
    return tgt.clone().index_add_(axis, idx, src)
def _segment_sum(src, seg, n):
    out = torch.zeros((n,) + src.shape[1:], dtype=src.dtype)
    return out.index_add_(0, seg, src)
def _pad(x, pw):
    flat = tuple(v for pair in reversed(pw) for v in pair)
    return torch.nn.functional.pad(x, flat)

kernel_name = 'concat_heads__sliding_block_cached__gqa_block_cached__decode'

def setup_inputs():

    _w = (lambda a: (lambda t: t.to(torch.bfloat16) if t.is_floating_point() else t)(torch.as_tensor(a)))
    def _A_setup():
        B, Sq, D = 1, 1, 576
        Hq, Hkv, Sk, Dh = 32, 16, 8192, 128
        assert Hq % Hkv == 0, (Hq, Hkv)
        return {
            "x": _w((lambda *s: torch.randn(*s, dtype=torch.bfloat16) * 0.8)(B, Sq, D)),
            "k_cache": _w((lambda *s: torch.randn(*s, dtype=torch.bfloat16) * 1.6)(B, Hkv, Sk, Dh)),
            "v_cache": _w((lambda *s: torch.randn(*s, dtype=torch.bfloat16) * 0.2)(B, Hkv, Sk, Dh)),
            "wq": _w((lambda *s: torch.randn(*s, dtype=torch.bfloat16) * 1.6)(D, Hq * Dh) * (D ** -0.5)),
            "wo": _w((lambda *s: torch.randn(*s, dtype=torch.bfloat16) * 0.2)(Hq * Dh, D) * ((Hq * Dh) ** -0.5)),
        }
    _A_in = _A_setup()

    def _B_setup():
        B, Sq, D = 1, 1, 576
        Hq, Hkv, Sk, Dh = 32, 16, 8192, 128
        assert Hq % Hkv == 0, (Hq, Hkv)
        return {
            "x": _w((lambda *s: torch.randn(*s, dtype=torch.bfloat16) * 0.8)(B, Sq, D)),
            "k_cache": _w((lambda *s: torch.randn(*s, dtype=torch.bfloat16) * 1.6)(B, Hkv, Sk, Dh)),
            "v_cache": _w((lambda *s: torch.randn(*s, dtype=torch.bfloat16) * 0.2)(B, Hkv, Sk, Dh)),
            "wq": _w((lambda *s: torch.randn(*s, dtype=torch.bfloat16) * 1.6)(D, Hq * Dh) * (D ** -0.5)),
            "wo": _w((lambda *s: torch.randn(*s, dtype=torch.bfloat16) * 0.2)(Hq * Dh, D) * ((Hq * Dh) ** -0.5)),
        }
    _B_in = _B_setup()

    return {
        "A_x": _A_in["x"],
        "A_k_cache": _A_in["k_cache"],
        "A_v_cache": _A_in["v_cache"],
        "A_wq": _A_in["wq"],
        "A_wo": _A_in["wo"],
        "B_x": _B_in["x"],
        "B_k_cache": _B_in["k_cache"],
        "B_v_cache": _B_in["v_cache"],
        "B_wq": _B_in["wq"],
        "B_wo": _B_in["wo"],
    }

def reference(A_x, A_k_cache, A_v_cache, A_wq, A_wo, B_x, B_k_cache, B_v_cache, B_wq, B_wo):
    def _A_ref(x, k_cache, v_cache, wq, wo):
        B, Sq, D = x.shape
        Hq, Dh = 32, 128
        Hkv, Sk = k_cache.shape[1], k_cache.shape[2]
        W = min(4096, max(256, Sk // 4))
        rep = Hq // Hkv
        q = (lambda x, *d: x.permute(*d))((x @ wq).reshape(B, Sq, Hq, Dh), 0, 2, 1, 3)
        k = (lambda x, n, axis: torch.repeat_interleave(x, n, dim=axis))(k_cache[:, :, Sk - W:, :], rep, axis=1)
        v = (lambda x, n, axis: torch.repeat_interleave(x, n, dim=axis))(v_cache[:, :, Sk - W:, :], rep, axis=1)
        scores = torch.einsum("bhqd,bhkd->bhqk", q, k) * (Dh ** -0.5)
        p = _softmax(scores, axis=-1)
        o = torch.einsum("bhqk,bhkd->bhqd", p, v)
        return (lambda x, *d: x.permute(*d))(o, 0, 2, 1, 3).reshape(B, Sq, Hq * Dh) @ wo

    def _B_ref(x, k_cache, v_cache, wq, wo):
        B, Sq, D = x.shape
        Hq, Dh = 32, 128
        Hkv = k_cache.shape[1]
        rep = Hq // Hkv
        q = (lambda x, *d: x.permute(*d))((x @ wq).reshape(B, Sq, Hq, Dh), 0, 2, 1, 3)
        k = (lambda x, n, axis: torch.repeat_interleave(x, n, dim=axis))(k_cache, rep, axis=1)
        v = (lambda x, n, axis: torch.repeat_interleave(x, n, dim=axis))(v_cache, rep, axis=1)
        scores = torch.einsum("bhqd,bhkd->bhqk", q, k) * (Dh ** -0.5)
        p = _softmax(scores, axis=-1)
        o = torch.einsum("bhqk,bhkd->bhqd", p, v)
        return (lambda x, *d: x.permute(*d))(o, 0, 2, 1, 3).reshape(B, Sq, Hq * Dh) @ wo

    a = _A_ref(A_x, A_k_cache, A_v_cache, A_wq, A_wo)
    b = _B_ref(B_x, B_k_cache, B_v_cache, B_wq, B_wo)
    return torch.concatenate([a, b], axis=-1)
```

```asm
; @launch grid=(256,1,1) block=(768,1,1) lds=19456
.amdgcn_target "amdgcn-amd-amdhsa--gfx950"
.text
.globl concat_heads__sliding_block_cached__gqa_block_cached__decode_kernel
.p2align 8
.type concat_heads__sliding_block_cached__gqa_block_cached__decode_kernel,@function
concat_heads__sliding_block_cached__gqa_block_cached__decode_kernel:
    s_load_dwordx16 s[4:19], s[0:1], 0
    s_load_dwordx8 s[20:27], s[0:1], 64
    s_load_dwordx2 s[28:29], s[0:1], 96
    v_lshrrev_b32 v1, 6, v0
    s_cmp_ge_u32 s2, 256
    s_cbranch_scc1 L_end
    v_readfirstlane_b32 s3, v1
    v_and_b32 v0, 63, v0
    s_and_b32 s30, s2, 7
    s_lshl_b32 s30, s30, 1
    s_lshr_b32 s48, s2, 7
    s_add_u32 s30, s30, s48
    s_add_u32 s30, s30, 12
    s_and_b32 s30, s30, 15
    s_bfe_u32 s31, s2, 0x40003
    s_mov_b32 s35, 0x20000
    s_mov_b32 s39, 0x20000
    s_mov_b32 s43, 0x20000
    s_mov_b32 s42, 1507328
    s_cmp_eq_u32 s3, 0
    s_cbranch_scc1 L_svc
    v_mov_b32 v2, 0
    v_mov_b32 v6, 0
    v_lshlrev_b32 v3, 2, v0
    ds_write_b32 v3, v2
    v_lshlrev_b32 v3, 4, v0
    v_cmp_eq_u32 vcc, 0, v0
    s_nop 1
    v_cndmask_b32 v167, 0, 1, vcc
    s_mov_b32 s63, 0
    s_cmp_lt_u32 s3, 3
    s_cselect_b32 s45, 0, 1
    s_cbranch_scc1 L_back
    s_mov_b64 exec, 0
    s_bitcmp1_b32 s3, 0
    s_cbranch_scc1 L_kvgo
    s_branch L_kvg2
L_back:
    s_setprio 0
    s_mov_b64 exec, -1
    v_and_b32 v4, 3, v0
    v_lshlrev_b32 v4, 4, v4
    v_lshrrev_b32 v5, 4, v0
    v_lshl_add_u32 v4, v5, 6, v4
    v_bfe_u32 v6, v0, 2, 2
    v_lshl_add_u32 v6, v6, 8, v4
    s_add_u32 s53, s3, 5
    s_and_b32 s53, s53, 7
    s_lshl_b32 s53, s53, 18
    s_lshl_b32 s52, s31, 14
    s_add_u32 s52, s52, s53
    s_lshl_b32 s53, s30, 21
    s_add_u32 s52, s52, s53
    s_bfe_u32 s48, s31, 0x20001
    s_lshl_b32 s48, s48, 12
    s_add_u32 s52, s52, s48
    s_xor_b32 s53, s52, 4096
    s_xor_b32 s54, s52, 8192
    s_xor_b32 s55, s52, 12288
    s_mov_b32 s34, 0x2000000
    s_mov_b32 s38, 0x2000000
    s_lshl_b32 s56, s3, 1
    s_min_u32 s57, s56, 19
    s_sub_i32 s56, s56, 3
    s_max_i32 s56, s56, 0
    s_cmp_lg_u32 s63, 0
    s_cbranch_scc1 L_kvgo
    s_mov_b32 s63, 1
    s_cmp_eq_u32 s45, 0
    s_waitcnt lgkmcnt(0)
    s_cselect_b32 s32, s6, s16
    s_cselect_b32 s33, s7, s17
    s_cselect_b32 s36, s8, s18
    s_cselect_b32 s37, s9, s19
    s_mov_b32 s40, s28
    s_mov_b32 s41, s29
    s_barrier
    s_cmp_ge_u32 s3, 4
    s_cbranch_scc1 L_warm
L_kvgo:
    s_mov_b32 s62, 0x80000
    s_cbranch_execz L_lpx2
L_lp1:
    ds_read_b32 v5, v2 offset:16
    s_waitcnt lgkmcnt(0)
    v_cmp_le_u32 vcc, s56, v5
    s_cbranch_vccnz L_lpx2
    s_sleep 2
    s_sub_u32 s62, s62, 1
    s_cbranch_scc0 L_lp1
L_lpx2:
    s_cbranch_execz L_back
    buffer_load_dwordx4 v[8:11], v6, s[32:35], s52 offen offset:0 nt
    buffer_load_dwordx4 v[12:15], v6, s[32:35], s52 offen offset:1024 nt
    buffer_load_dwordx4 v[16:19], v6, s[32:35], s52 offen offset:2048 nt
    buffer_load_dwordx4 v[20:23], v6, s[32:35], s52 offen offset:3072 nt
    buffer_load_dwordx4 v[24:27], v6, s[32:35], s53 offen offset:0 nt
    buffer_load_dwordx4 v[28:31], v6, s[32:35], s53 offen offset:1024 nt
    buffer_load_dwordx4 v[32:35], v6, s[32:35], s53 offen offset:2048 nt
    buffer_load_dwordx4 v[36:39], v6, s[32:35], s53 offen offset:3072 nt
    buffer_load_dwordx4 v[40:43], v6, s[32:35], s54 offen offset:0 nt
    buffer_load_dwordx4 v[44:47], v6, s[32:35], s54 offen offset:1024 nt
    buffer_load_dwordx4 v[48:51], v6, s[32:35], s54 offen offset:2048 nt
    buffer_load_dwordx4 v[52:55], v6, s[32:35], s54 offen offset:3072 nt
    buffer_load_dwordx4 v[56:59], v6, s[32:35], s55 offen offset:0 nt
    buffer_load_dwordx4 v[60:63], v6, s[32:35], s55 offen offset:1024 nt
    buffer_load_dwordx4 v[64:67], v6, s[32:35], s55 offen offset:2048 nt
    buffer_load_dwordx4 v[68:71], v6, s[32:35], s55 offen offset:3072 nt
L_kvg2:
    ds_add_u32 v2, v167 offset:16
    s_mov_b32 s62, 0x80000
    s_cbranch_execz L_lpx4
L_lp3:
    ds_read_b32 v5, v2 offset:16
    s_waitcnt lgkmcnt(0)
    v_cmp_le_u32 vcc, s57, v5
    s_cbranch_vccnz L_lpx4
    s_sleep 1
    s_sub_u32 s62, s62, 1
    s_cbranch_scc0 L_lp3
L_lpx4:
    s_cbranch_execz L_back
    buffer_load_dwordx4 v[72:75], v3, s[36:39], s52 offen offset:0 nt
    buffer_load_dwordx4 v[76:79], v3, s[36:39], s52 offen offset:1024 nt
    buffer_load_dwordx4 v[80:83], v3, s[36:39], s52 offen offset:2048 nt
    buffer_load_dwordx4 v[84:87], v3, s[36:39], s52 offen offset:3072 nt
    buffer_load_dwordx4 v[88:91], v3, s[36:39], s53 offen offset:0 nt
    buffer_load_dwordx4 v[92:95], v3, s[36:39], s53 offen offset:1024 nt
    buffer_load_dwordx4 v[96:99], v3, s[36:39], s53 offen offset:2048 nt
    buffer_load_dwordx4 v[100:103], v3, s[36:39], s53 offen offset:3072 nt
    buffer_load_dwordx4 v[104:107], v3, s[36:39], s54 offen offset:0 nt
    buffer_load_dwordx4 v[108:111], v3, s[36:39], s54 offen offset:1024 nt
    buffer_load_dwordx4 v[112:115], v3, s[36:39], s54 offen offset:2048 nt
    buffer_load_dwordx4 v[116:119], v3, s[36:39], s54 offen offset:3072 nt
    buffer_load_dwordx4 v[120:123], v3, s[36:39], s55 offen offset:0 nt
    buffer_load_dwordx4 v[124:127], v3, s[36:39], s55 offen offset:1024 nt
    buffer_load_dwordx4 v[128:131], v3, s[36:39], s55 offen offset:2048 nt
    buffer_load_dwordx4 v[132:135], v3, s[36:39], s55 offen offset:3072 nt
L_c1:
    ds_add_u32 v2, v167 offset:16
    v_bfe_u32 v5, v0, 3, 1
    v_lshl_add_u32 v4, v5, 8, v4
    s_lshl_b32 s56, s45, 9
    v_add_u32 v4, s56, v4
    v_and_b32 v5, 1, v0
    v_lshlrev_b32 v5, 4, v5
    v_mov_b32 v6, 0xffff
    v_lshlrev_b32 v5, v5, v6
    v_bfe_u32 v6, v0, 1, 2
    v_cmp_eq_u32 vcc, 0, v6
    s_nop 1
    v_cndmask_b32 v160, 0, v5, vcc
    v_cmp_eq_u32 vcc, 1, v6
    s_nop 1
    v_cndmask_b32 v161, 0, v5, vcc
    v_cmp_eq_u32 vcc, 2, v6
    s_nop 1
    v_cndmask_b32 v162, 0, v5, vcc
    v_cmp_eq_u32 vcc, 3, v6
    s_nop 1
    v_cndmask_b32 v163, 0, v5, vcc
    v_mov_b32 v7, 0x3e0293ee
    s_lshl_b32 s59, s30, 4
    s_add_u32 s59, s59, s31
    s_lshl_b32 s59, s59, 1
    s_add_u32 s59, s59, s45
    s_mul_i32 s59, s59, 1152
    s_add_u32 s59, s59, 278528
    s_mov_b32 s62, 0x80000
    s_cbranch_execz L_lpx6
L_lp5:
    ds_read_b32 v5, v2 offset:0
    s_waitcnt lgkmcnt(0)
    v_cmp_ne_u32 vcc, 0, v5
    s_cbranch_vccnz L_lpx6
    s_sleep 2
    s_sub_u32 s62, s62, 1
    s_cbranch_scc0 L_lp5
L_lpx6:
    s_setprio 2
    ds_read_b128 v[136:139], v4 offset:512
    ds_read_b64 v[164:165], v2 offset:8
    s_waitcnt lgkmcnt(0)
    v_mov_b32 v1, v164
    v_readfirstlane_b32 s61, v165
    s_waitcnt vmcnt(28)
    v_mfma_f32_16x16x32_bf16 v[140:143], v[8:11], v[136:139], 0
    v_mfma_f32_16x16x32_bf16 v[8:11], v[12:15], v[136:139], 0
    v_mfma_f32_16x16x32_bf16 v[12:15], v[16:19], v[136:139], 0
    v_mfma_f32_16x16x32_bf16 v[16:19], v[20:23], v[136:139], 0
    s_waitcnt vmcnt(24)
    v_mfma_f32_16x16x32_bf16 v[20:23], v[24:27], v[136:139], 0
    v_mfma_f32_16x16x32_bf16 v[24:27], v[28:31], v[136:139], 0
    v_mfma_f32_16x16x32_bf16 v[28:31], v[32:35], v[136:139], 0
    v_mfma_f32_16x16x32_bf16 v[32:35], v[36:39], v[136:139], 0
    v_mul_f32_dpp v144, v140, v7 quad_perm:[0,0,0,0] row_mask:0xf bank_mask:0xf
    v_mul_f32_dpp v145, v8, v7 quad_perm:[0,0,0,0] row_mask:0xf bank_mask:0xf
    v_mul_f32_dpp v146, v12, v7 quad_perm:[0,0,0,0] row_mask:0xf bank_mask:0xf
    v_mul_f32_dpp v147, v16, v7 quad_perm:[0,0,0,0] row_mask:0xf bank_mask:0xf
    v_fmac_f32_dpp v144, v141, v7 quad_perm:[1,1,1,1] row_mask:0xf bank_mask:0xf
    v_fmac_f32_dpp v145, v9, v7 quad_perm:[1,1,1,1] row_mask:0xf bank_mask:0xf
    v_fmac_f32_dpp v146, v13, v7 quad_perm:[1,1,1,1] row_mask:0xf bank_mask:0xf
    v_fmac_f32_dpp v147, v17, v7 quad_perm:[1,1,1,1] row_mask:0xf bank_mask:0xf
    v_fmac_f32_dpp v144, v142, v7 quad_perm:[2,2,2,2] row_mask:0xf bank_mask:0xf
    v_fmac_f32_dpp v145, v10, v7 quad_perm:[2,2,2,2] row_mask:0xf bank_mask:0xf
    v_fmac_f32_dpp v146, v14, v7 quad_perm:[2,2,2,2] row_mask:0xf bank_mask:0xf
    v_fmac_f32_dpp v147, v18, v7 quad_perm:[2,2,2,2] row_mask:0xf bank_mask:0xf
    v_fmac_f32_dpp v144, v143, v7 quad_perm:[3,3,3,3] row_mask:0xf bank_mask:0xf
    v_fmac_f32_dpp v145, v11, v7 quad_perm:[3,3,3,3] row_mask:0xf bank_mask:0xf
    v_fmac_f32_dpp v146, v15, v7 quad_perm:[3,3,3,3] row_mask:0xf bank_mask:0xf
    v_fmac_f32_dpp v147, v19, v7 quad_perm:[3,3,3,3] row_mask:0xf bank_mask:0xf
    s_waitcnt vmcnt(20)
    v_mfma_f32_16x16x32_bf16 v[36:39], v[40:43], v[136:139], 0
    v_mfma_f32_16x16x32_bf16 v[40:43], v[44:47], v[136:139], 0
    v_mfma_f32_16x16x32_bf16 v[44:47], v[48:51], v[136:139], 0
    v_mfma_f32_16x16x32_bf16 v[48:51], v[52:55], v[136:139], 0
    v_mul_f32_dpp v148, v20, v7 quad_perm:[0,0,0,0] row_mask:0xf bank_mask:0xf
    v_mul_f32_dpp v149, v24, v7 quad_perm:[0,0,0,0] row_mask:0xf bank_mask:0xf
    v_mul_f32_dpp v150, v28, v7 quad_perm:[0,0,0,0] row_mask:0xf bank_mask:0xf
    v_mul_f32_dpp v151, v32, v7 quad_perm:[0,0,0,0] row_mask:0xf bank_mask:0xf
    v_fmac_f32_dpp v148, v21, v7 quad_perm:[1,1,1,1] row_mask:0xf bank_mask:0xf
    v_fmac_f32_dpp v149, v25, v7 quad_perm:[1,1,1,1] row_mask:0xf bank_mask:0xf
    v_fmac_f32_dpp v150, v29, v7 quad_perm:[1,1,1,1] row_mask:0xf bank_mask:0xf
    v_fmac_f32_dpp v151, v33, v7 quad_perm:[1,1,1,1] row_mask:0xf bank_mask:0xf
    v_fmac_f32_dpp v148, v22, v7 quad_perm:[2,2,2,2] row_mask:0xf bank_mask:0xf
    v_fmac_f32_dpp v149, v26, v7 quad_perm:[2,2,2,2] row_mask:0xf bank_mask:0xf
    v_fmac_f32_dpp v150, v30, v7 quad_perm:[2,2,2,2] row_mask:0xf bank_mask:0xf
    v_fmac_f32_dpp v151, v34, v7 quad_perm:[2,2,2,2] row_mask:0xf bank_mask:0xf
    v_fmac_f32_dpp v148, v23, v7 quad_perm:[3,3,3,3] row_mask:0xf bank_mask:0xf
    v_fmac_f32_dpp v149, v27, v7 quad_perm:[3,3,3,3] row_mask:0xf bank_mask:0xf
    v_fmac_f32_dpp v150, v31, v7 quad_perm:[3,3,3,3] row_mask:0xf bank_mask:0xf
    v_fmac_f32_dpp v151, v35, v7 quad_perm:[3,3,3,3] row_mask:0xf bank_mask:0xf
    s_waitcnt vmcnt(16)
    v_mfma_f32_16x16x32_bf16 v[52:55], v[56:59], v[136:139], 0
    v_mfma_f32_16x16x32_bf16 v[56:59], v[60:63], v[136:139], 0
    v_mfma_f32_16x16x32_bf16 v[60:63], v[64:67], v[136:139], 0
    v_mfma_f32_16x16x32_bf16 v[64:67], v[68:71], v[136:139], 0
    v_mul_f32_dpp v152, v36, v7 quad_perm:[0,0,0,0] row_mask:0xf bank_mask:0xf
    v_mul_f32_dpp v153, v40, v7 quad_perm:[0,0,0,0] row_mask:0xf bank_mask:0xf
    v_mul_f32_dpp v154, v44, v7 quad_perm:[0,0,0,0] row_mask:0xf bank_mask:0xf
    v_mul_f32_dpp v155, v48, v7 quad_perm:[0,0,0,0] row_mask:0xf bank_mask:0xf
    v_fmac_f32_dpp v152, v37, v7 quad_perm:[1,1,1,1] row_mask:0xf bank_mask:0xf
    v_fmac_f32_dpp v153, v41, v7 quad_perm:[1,1,1,1] row_mask:0xf bank_mask:0xf
    v_fmac_f32_dpp v154, v45, v7 quad_perm:[1,1,1,1] row_mask:0xf bank_mask:0xf
    v_fmac_f32_dpp v155, v49, v7 quad_perm:[1,1,1,1] row_mask:0xf bank_mask:0xf
    v_fmac_f32_dpp v152, v38, v7 quad_perm:[2,2,2,2] row_mask:0xf bank_mask:0xf
    v_fmac_f32_dpp v153, v42, v7 quad_perm:[2,2,2,2] row_mask:0xf bank_mask:0xf
    v_fmac_f32_dpp v154, v46, v7 quad_perm:[2,2,2,2] row_mask:0xf bank_mask:0xf
    v_fmac_f32_dpp v155, v50, v7 quad_perm:[2,2,2,2] row_mask:0xf bank_mask:0xf
    v_fmac_f32_dpp v152, v39, v7 quad_perm:[3,3,3,3] row_mask:0xf bank_mask:0xf
    v_fmac_f32_dpp v153, v43, v7 quad_perm:[3,3,3,3] row_mask:0xf bank_mask:0xf
    v_fmac_f32_dpp v154, v47, v7 quad_perm:[3,3,3,3] row_mask:0xf bank_mask:0xf
    v_fmac_f32_dpp v155, v51, v7 quad_perm:[3,3,3,3] row_mask:0xf bank_mask:0xf
    v_mul_f32_dpp v156, v52, v7 quad_perm:[0,0,0,0] row_mask:0xf bank_mask:0xf
    v_mul_f32_dpp v157, v56, v7 quad_perm:[0,0,0,0] row_mask:0xf bank_mask:0xf
    v_mul_f32_dpp v158, v60, v7 quad_perm:[0,0,0,0] row_mask:0xf bank_mask:0xf
    v_mul_f32_dpp v159, v64, v7 quad_perm:[0,0,0,0] row_mask:0xf bank_mask:0xf
    v_fmac_f32_dpp v156, v53, v7 quad_perm:[1,1,1,1] row_mask:0xf bank_mask:0xf
    v_fmac_f32_dpp v157, v57, v7 quad_perm:[1,1,1,1] row_mask:0xf bank_mask:0xf
    v_fmac_f32_dpp v158, v61, v7 quad_perm:[1,1,1,1] row_mask:0xf bank_mask:0xf
    v_fmac_f32_dpp v159, v65, v7 quad_perm:[1,1,1,1] row_mask:0xf bank_mask:0xf
    v_fmac_f32_dpp v156, v54, v7 quad_perm:[2,2,2,2] row_mask:0xf bank_mask:0xf
    v_fmac_f32_dpp v157, v58, v7 quad_perm:[2,2,2,2] row_mask:0xf bank_mask:0xf
    v_fmac_f32_dpp v158, v62, v7 quad_perm:[2,2,2,2] row_mask:0xf bank_mask:0xf
    v_fmac_f32_dpp v159, v66, v7 quad_perm:[2,2,2,2] row_mask:0xf bank_mask:0xf
    v_fmac_f32_dpp v156, v55, v7 quad_perm:[3,3,3,3] row_mask:0xf bank_mask:0xf
    v_fmac_f32_dpp v157, v59, v7 quad_perm:[3,3,3,3] row_mask:0xf bank_mask:0xf
    v_fmac_f32_dpp v158, v63, v7 quad_perm:[3,3,3,3] row_mask:0xf bank_mask:0xf
    v_fmac_f32_dpp v159, v67, v7 quad_perm:[3,3,3,3] row_mask:0xf bank_mask:0xf
    s_cbranch_execz L_back
L_c2:
    v_max3_f32 v5, v144, v145, v146
    v_max3_f32 v6, v147, v148, v149
    v_max3_f32 v5, v5, v150, v151
    v_max3_f32 v6, v6, v152, v153
    v_max3_f32 v5, v5, v154, v155
    v_max3_f32 v6, v6, v156, v157
    v_max3_f32 v5, v5, v158, v159
    v_max_f32 v5, v5, v6
    v_mov_b32 v6, v5
    s_nop 1
    v_permlane32_swap_b32 v5, v6
    v_max_f32 v5, v5, v6
    v_mov_b32 v6, v5
    s_nop 1
    v_permlane16_swap_b32 v5, v6
    v_max_f32 v5, v5, v6
    v_sub_f32 v144, v144, v5
    v_sub_f32 v145, v145, v5
    v_sub_f32 v146, v146, v5
    v_sub_f32 v147, v147, v5
    v_sub_f32 v148, v148, v5
    v_sub_f32 v149, v149, v5
    v_sub_f32 v150, v150, v5
    v_sub_f32 v151, v151, v5
    v_sub_f32 v152, v152, v5
    v_sub_f32 v153, v153, v5
    v_sub_f32 v154, v154, v5
    v_sub_f32 v155, v155, v5
    v_sub_f32 v156, v156, v5
    v_sub_f32 v157, v157, v5
    v_sub_f32 v158, v158, v5
    v_sub_f32 v159, v159, v5
    v_exp_f32 v144, v144
    v_exp_f32 v145, v145
    v_exp_f32 v146, v146
    v_exp_f32 v147, v147
    v_exp_f32 v148, v148
    v_exp_f32 v149, v149
    v_exp_f32 v150, v150
    v_exp_f32 v151, v151
    v_exp_f32 v152, v152
    v_exp_f32 v153, v153
    v_exp_f32 v154, v154
    v_exp_f32 v155, v155
    v_exp_f32 v156, v156
    v_exp_f32 v157, v157
    v_exp_f32 v158, v158
    v_exp_f32 v159, v159
    v_add_f32 v6, v144, v145
    v_add_f32 v4, v146, v147
    v_add_f32 v6, v6, v148
    v_add_f32 v4, v4, v149
    v_add_f32 v6, v6, v150
    v_add_f32 v4, v4, v151
    v_add_f32 v6, v6, v152
    v_add_f32 v4, v4, v153
    v_add_f32 v6, v6, v154
    v_add_f32 v4, v4, v155
    v_add_f32 v6, v6, v156
    v_add_f32 v4, v4, v157
    v_add_f32 v6, v6, v158
    v_add_f32 v4, v4, v159
    v_add_f32 v6, v6, v4
    v_cvt_pk_bf16_f32 v144, v144, v144
    v_cvt_pk_bf16_f32 v145, v145, v145
    v_cvt_pk_bf16_f32 v146, v146, v146
    v_cvt_pk_bf16_f32 v147, v147, v147
    v_cvt_pk_bf16_f32 v148, v148, v148
    v_cvt_pk_bf16_f32 v149, v149, v149
    v_cvt_pk_bf16_f32 v150, v150, v150
    v_cvt_pk_bf16_f32 v151, v151, v151
    v_cvt_pk_bf16_f32 v152, v152, v152
    v_cvt_pk_bf16_f32 v153, v153, v153
    v_cvt_pk_bf16_f32 v154, v154, v154
    v_cvt_pk_bf16_f32 v155, v155, v155
    v_cvt_pk_bf16_f32 v156, v156, v156
    v_cvt_pk_bf16_f32 v157, v157, v157
    v_cvt_pk_bf16_f32 v158, v158, v158
    v_cvt_pk_bf16_f32 v159, v159, v159
    v_and_b32 v8, v144, v160
    v_and_b32 v9, v144, v161
    v_and_b32 v10, v144, v162
    v_and_b32 v11, v144, v163
    v_and_b32 v12, v145, v160
    v_and_b32 v13, v145, v161
    v_and_b32 v14, v145, v162
    v_and_b32 v15, v145, v163
    v_and_b32 v16, v146, v160
    v_and_b32 v17, v146, v161
    v_and_b32 v18, v146, v162
    v_and_b32 v19, v146, v163
    v_and_b32 v20, v147, v160
    v_and_b32 v21, v147, v161
    v_and_b32 v22, v147, v162
    v_and_b32 v23, v147, v163
    v_and_b32 v24, v148, v160
    v_and_b32 v25, v148, v161
    v_and_b32 v26, v148, v162
    v_and_b32 v27, v148, v163
    v_and_b32 v28, v149, v160
    v_and_b32 v29, v149, v161
    v_and_b32 v30, v149, v162
    v_and_b32 v31, v149, v163
    v_and_b32 v32, v150, v160
    v_and_b32 v33, v150, v161
    v_and_b32 v34, v150, v162
    v_and_b32 v35, v150, v163
    v_and_b32 v36, v151, v160
    v_and_b32 v37, v151, v161
    v_and_b32 v38, v151, v162
    v_and_b32 v39, v151, v163
    v_and_b32 v40, v152, v160
    v_and_b32 v41, v152, v161
    v_and_b32 v42, v152, v162
    v_and_b32 v43, v152, v163
    v_and_b32 v44, v153, v160
    v_and_b32 v45, v153, v161
    v_and_b32 v46, v153, v162
    v_and_b32 v47, v153, v163
    v_and_b32 v48, v154, v160
    v_and_b32 v49, v154, v161
    v_and_b32 v50, v154, v162
    v_and_b32 v51, v154, v163
    v_and_b32 v52, v155, v160
    v_and_b32 v53, v155, v161
    v_and_b32 v54, v155, v162
    v_and_b32 v55, v155, v163
    v_and_b32 v56, v156, v160
    v_and_b32 v57, v156, v161
    v_and_b32 v58, v156, v162
    v_and_b32 v59, v156, v163
    v_and_b32 v60, v157, v160
    v_and_b32 v61, v157, v161
    v_and_b32 v62, v157, v162
    v_and_b32 v63, v157, v163
    v_and_b32 v64, v158, v160
    v_and_b32 v65, v158, v161
    v_and_b32 v66, v158, v162
    v_and_b32 v67, v158, v163
    v_and_b32 v68, v159, v160
    v_and_b32 v69, v159, v161
    v_and_b32 v70, v159, v162
    v_and_b32 v71, v159, v163
    v_mov_b32 v4, v6
    s_nop 1
    v_permlane32_swap_b32 v6, v4
    v_add_f32 v6, v6, v4
    v_mov_b32 v4, v6
    s_nop 1
    v_permlane16_swap_b32 v6, v4
    v_add_f32 v6, v6, v4
    v_mov_b32_dpp v140, v5 row_newbcast:0 row_mask:0x3 bank_mask:0xf
    s_nop 0
    v_mov_b32_dpp v141, v6 row_newbcast:0 row_mask:0x3 bank_mask:0xf
    v_mov_b32_dpp v140, v5 row_newbcast:8 row_mask:0xc bank_mask:0xf
    s_nop 0
    v_mov_b32_dpp v141, v6 row_newbcast:8 row_mask:0xc bank_mask:0xf
    s_cbranch_execz L_back
L_c3:
    s_lshl_b32 s56, s3, 10
    v_add_u32 v4, s56, v3
    v_lshrrev_b32 v5, 1, v4
    s_lshl_b32 s56, s3, 2
    v_mov_b32 v6, s56
    v_mov_b32 v142, 1.0
    v_mov_b32 v144, 0
    v_mov_b32 v145, 0
    v_mov_b32 v146, 0
    v_mov_b32 v147, 0
    s_and_b32 s58, s3, 7
    s_cmp_eq_u32 s58, 2
    s_cbranch_scc0 L_pv
    s_mov_b32 s62, 0x80000
    s_cbranch_execz L_lpx8
L_lp7:
    ds_read_b32 v143, v6 offset:28
    s_waitcnt lgkmcnt(0)
    v_cmp_ne_u32 vcc, 0, v143
    s_cbranch_vccnz L_lpx8
    s_sleep 1
    s_sub_u32 s62, s62, 1
    s_cbranch_scc0 L_lp7
L_lpx8:
    ds_read_b64 v[148:149], v5 offset:12800
    ds_read_b128 v[144:147], v4 offset:1024
    s_waitcnt lgkmcnt(1)
    v_max_f32 v150, v140, v148
    v_sub_f32 v142, v140, v150
    v_sub_f32 v148, v148, v150
    v_exp_f32 v142, v142
    v_exp_f32 v148, v148
    v_mov_b32 v140, v150
    v_mul_f32 v141, v141, v142
    v_fmac_f32 v141, v149, v148
    s_waitcnt lgkmcnt(0)
    v_mul_f32 v144, v144, v148
    v_mul_f32 v145, v145, v148
    v_mul_f32 v146, v146, v148
    v_mul_f32 v147, v147, v148
    v_mov_b32 v149, v1
    v_mov_b32 v151, v1
    v_mov_b32 v153, v1
    v_mov_b32 v155, v1
    v_mov_b32 v156, v140
    v_mov_b32 v157, v1
    v_mov_b32 v158, v141
    v_mov_b32 v159, v1
    v_and_b32 v5, 31, v0
    v_lshlrev_b32 v5, 22, v5
    v_lshrrev_b32 v6, 5, v0
    v_lshl_add_u32 v5, v6, 8, v5
    s_lshl_b32 s57, s30, 10
    s_lshl_b32 s56, s45, 9
    s_add_u32 s57, s57, s56
    s_lshl_b32 s56, s31, 4
    s_add_u32 s57, s57, s56
    s_add_u32 s57, s57, 1478656
L_pv:
    s_waitcnt vmcnt(15)
    v_mfma_f32_16x16x32_bf16 v[136:139], v[8:11], v[72:75], 0
    s_waitcnt vmcnt(14)
    v_mfma_f32_16x16x32_bf16 v[136:139], v[12:15], v[76:79], v[136:139]
    s_waitcnt vmcnt(13)
    v_mfma_f32_16x16x32_bf16 v[136:139], v[16:19], v[80:83], v[136:139]
    s_waitcnt vmcnt(12)
    v_mfma_f32_16x16x32_bf16 v[136:139], v[20:23], v[84:87], v[136:139]
    s_waitcnt vmcnt(11)
    v_mfma_f32_16x16x32_bf16 v[136:139], v[24:27], v[88:91], v[136:139]
    s_waitcnt vmcnt(10)
    v_mfma_f32_16x16x32_bf16 v[136:139], v[28:31], v[92:95], v[136:139]
    s_waitcnt vmcnt(9)
    v_mfma_f32_16x16x32_bf16 v[136:139], v[32:35], v[96:99], v[136:139]
    s_waitcnt vmcnt(8)
    v_mfma_f32_16x16x32_bf16 v[136:139], v[36:39], v[100:103], v[136:139]
    s_waitcnt vmcnt(7)
    v_mfma_f32_16x16x32_bf16 v[136:139], v[40:43], v[104:107], v[136:139]
    s_waitcnt vmcnt(6)
    v_mfma_f32_16x16x32_bf16 v[136:139], v[44:47], v[108:111], v[136:139]
    s_waitcnt vmcnt(5)
    v_mfma_f32_16x16x32_bf16 v[136:139], v[48:51], v[112:115], v[136:139]
    s_waitcnt vmcnt(4)
    v_mfma_f32_16x16x32_bf16 v[136:139], v[52:55], v[116:119], v[136:139]
    s_waitcnt vmcnt(3)
    v_mfma_f32_16x16x32_bf16 v[136:139], v[56:59], v[120:123], v[136:139]
    s_waitcnt vmcnt(2)
    v_mfma_f32_16x16x32_bf16 v[136:139], v[60:63], v[124:127], v[136:139]
    s_waitcnt vmcnt(1)
    v_mfma_f32_16x16x32_bf16 v[136:139], v[64:67], v[128:131], v[136:139]
    s_waitcnt vmcnt(0)
    v_mfma_f32_16x16x32_bf16 v[136:139], v[68:71], v[132:135], v[136:139]
    s_cmp_eq_u32 s58, 2
    s_cbranch_scc1 L_last
    s_cmp_le_u32 s3, 3
    s_cbranch_scc1 L_first
    s_mov_b32 s62, 0x80000
    s_cbranch_execz L_lpx10
L_lp9:
    ds_read_b32 v143, v6 offset:28
    s_waitcnt lgkmcnt(0)
    v_cmp_ne_u32 vcc, 0, v143
    s_cbranch_vccnz L_lpx10
    s_sleep 1
    s_sub_u32 s62, s62, 1
    s_cbranch_scc0 L_lp9
L_lpx10:
    ds_read_b64 v[148:149], v5 offset:12800
    ds_read_b128 v[144:147], v4 offset:1024
    s_waitcnt lgkmcnt(1)
    v_max_f32 v150, v140, v148
    v_sub_f32 v142, v140, v150
    v_sub_f32 v148, v148, v150
    v_exp_f32 v142, v142
    v_exp_f32 v148, v148
    v_mov_b32 v140, v150
    v_mul_f32 v141, v141, v142
    v_fmac_f32 v141, v149, v148
    s_waitcnt lgkmcnt(0)
    v_mul_f32 v144, v144, v148
    v_mul_f32 v145, v145, v148
    v_mul_f32 v146, v146, v148
    v_mul_f32 v147, v147, v148
L_first:
    s_nop 7
    v_fmac_f32 v144, v136, v142
    v_fmac_f32 v145, v137, v142
    v_fmac_f32 v146, v138, v142
    v_fmac_f32 v147, v139, v142
    ds_write_b128 v4, v[144:147] offset:2048
    ds_write_b64 v5, v[140:141] offset:13312
    v_mov_b32 v7, 1
    ds_write_b32 v6, v7 offset:32
    s_cbranch_execz L_back
    s_cmp_eq_u32 s3, 9
    s_cbranch_scc1 L_finb
    s_branch L_wo
L_last:
    s_cbranch_execz L_back
    s_cmp_eq_u32 s61, 0
    s_cbranch_scc1 L_slow
    buffer_store_dwordx4 v[156:159], v5, s[40:43], s57 offen
    s_nop 1
    v_fmac_f32 v144, v136, v142
    v_fmac_f32 v145, v137, v142
    v_fmac_f32 v146, v138, v142
    v_fmac_f32 v147, v139, v142
    v_cvt_pk_bf16_f32 v148, v144, v145
    v_cvt_pk_bf16_f32 v150, v146, v147
    buffer_store_dwordx4 v[148:151], v3, s[40:43], s59 offen
    s_branch L_pubd
L_slow:
    buffer_store_dwordx4 v[156:159], v5, s[40:43], s57 offen sc1
    s_nop 1
    v_fmac_f32 v144, v136, v142
    v_fmac_f32 v145, v137, v142
    v_fmac_f32 v146, v138, v142
    v_fmac_f32 v147, v139, v142
    v_cvt_pk_bf16_f32 v148, v144, v145
    v_cvt_pk_bf16_f32 v150, v146, v147
    buffer_store_dwordx4 v[148:151], v3, s[40:43], s59 offen sc1
L_pubd:
    s_cmp_lg_u32 s3, 10
    s_cbranch_scc1 L_wo
    ds_add_u32 v2, v167 offset:16
L_finb:
    s_branch L_fin
L_warm:
    s_cmp_eq_u32 s3, 11
    s_cbranch_scc1 L_wo
    s_cmp_eq_u32 s3, 10
    s_cbranch_scc0 L_warm2
    s_buffer_load_dword s72, s[32:35], s52
    s_buffer_load_dword s73, s[36:39], s52
    s_cmp_lt_u32 s31, 8
    s_cselect_b32 s66, s12, s22
    s_cselect_b32 s67, s13, s23
    s_mul_i32 s68, s30, 294912
    s_load_dword s74, s[66:67], s68
    s_add_u32 s68, s68, 294908
    s_load_dword s75, s[66:67], s68
    s_load_dword s74, s[24:25], 0
    s_branch L_kvgo
L_warm2:
    s_mov_b64 exec, 0
    s_cmp_eq_u32 s3, 4
    s_cbranch_scc1 L_dot
    s_cmp_eq_u32 s3, 5
    s_cbranch_scc1 L_dot2
    s_cmp_eq_u32 s3, 6
    s_cbranch_scc1 L_gat
    s_cmp_eq_u32 s3, 7
    s_cbranch_scc1 L_c1
    s_cmp_eq_u32 s3, 8
    s_cbranch_scc1 L_c2
    s_branch L_c3
L_svc:
    s_mov_b32 s34, 4718592
    s_mov_b32 s38, 1152
    s_and_b32 s49, s31, 7
    s_mul_i32 s48, s49, 589824
    s_mul_i32 s63, s49, 144
    s_lshl_b32 s49, s30, 9
    s_add_u32 s48, s48, s49
    s_add_u32 s49, s48, 65536
    s_add_u32 s50, s48, 131072
    s_add_u32 s51, s48, 196608
    s_add_u32 s52, s48, 262144
    s_add_u32 s53, s48, 327680
    s_add_u32 s54, s48, 393216
    s_add_u32 s55, s48, 458752
    s_add_u32 s56, s48, 524288
    v_lshrrev_b32 v1, 5, v0
    v_lshlrev_b32 v1, 14, v1
    v_and_b32 v2, 31, v0
    v_lshl_add_u32 v1, v2, 4, v1
    v_add_u32 v2, 8192, v1
    v_add_u32 v3, 32768, v1
    v_add_u32 v4, 40960, v1
    s_add_u32 s57, s63, 64
    s_add_u32 s58, s63, 96
    s_add_u32 s59, s63, 128
    s_lshl_b32 s44, s30, 8
    s_add_u32 s44, s44, 1474560
    s_lshl_b32 s46, s31, 2
    s_add_u32 s46, s46, s44
    s_cmp_lt_u32 s31, 8
    s_waitcnt lgkmcnt(0)
    s_cselect_b32 s32, s10, s20
    s_cselect_b32 s33, s11, s21
    s_cselect_b32 s36, s4, s14
    s_cselect_b32 s37, s5, s15
    buffer_load_dwordx4 v[6:9], v1, s[32:35], s48 offen nt
    buffer_load_dwordx4 v[10:13], v2, s[32:35], s48 offen nt
    buffer_load_dwordx4 v[14:17], v3, s[32:35], s48 offen nt
    buffer_load_dwordx4 v[18:21], v4, s[32:35], s48 offen nt
    s_buffer_load_dwordx16 s[4:19], s[36:39], s63
    s_buffer_load_dwordx8 s[20:27], s[36:39], s57
    s_buffer_load_dwordx8 s[64:71], s[36:39], s58
    s_buffer_load_dwordx4 s[72:75], s[36:39], s59
    s_load_dword s60, s[28:29], 0
    s_mov_b32 s0, 0
    s_atomic_add s0, s[28:29], s46 glc
    buffer_load_dwordx4 v[22:25], v1, s[32:35], s49 offen nt
    buffer_load_dwordx4 v[26:29], v2, s[32:35], s49 offen nt
    buffer_load_dwordx4 v[30:33], v3, s[32:35], s49 offen nt
    buffer_load_dwordx4 v[34:37], v4, s[32:35], s49 offen nt
    buffer_load_dwordx4 v[38:41], v1, s[32:35], s50 offen nt
    buffer_load_dwordx4 v[42:45], v2, s[32:35], s50 offen nt
    buffer_load_dwordx4 v[46:49], v3, s[32:35], s50 offen nt
    buffer_load_dwordx4 v[50:53], v4, s[32:35], s50 offen nt
    buffer_load_dwordx4 v[54:57], v1, s[32:35], s51 offen nt
    buffer_load_dwordx4 v[58:61], v2, s[32:35], s51 offen nt
    buffer_load_dwordx4 v[62:65], v3, s[32:35], s51 offen nt
    buffer_load_dwordx4 v[66:69], v4, s[32:35], s51 offen nt
    buffer_load_dwordx4 v[70:73], v1, s[32:35], s52 offen nt
    buffer_load_dwordx4 v[74:77], v2, s[32:35], s52 offen nt
    buffer_load_dwordx4 v[78:81], v3, s[32:35], s52 offen nt
    buffer_load_dwordx4 v[82:85], v4, s[32:35], s52 offen nt
    buffer_load_dwordx4 v[86:89], v1, s[32:35], s53 offen nt
    buffer_load_dwordx4 v[90:93], v2, s[32:35], s53 offen nt
    buffer_load_dwordx4 v[94:97], v3, s[32:35], s53 offen nt
    buffer_load_dwordx4 v[98:101], v4, s[32:35], s53 offen nt
    buffer_load_dwordx4 v[102:105], v1, s[32:35], s54 offen nt
    buffer_load_dwordx4 v[106:109], v2, s[32:35], s54 offen nt
    buffer_load_dwordx4 v[110:113], v3, s[32:35], s54 offen nt
    buffer_load_dwordx4 v[114:117], v4, s[32:35], s54 offen nt
    buffer_load_dwordx4 v[118:121], v1, s[32:35], s55 offen nt
    buffer_load_dwordx4 v[122:125], v2, s[32:35], s55 offen nt
    buffer_load_dwordx4 v[126:129], v3, s[32:35], s55 offen nt
    buffer_load_dwordx4 v[130:133], v4, s[32:35], s55 offen nt
    buffer_load_dwordx4 v[134:137], v1, s[32:35], s56 offen nt
    buffer_load_dwordx4 v[138:141], v2, s[32:35], s56 offen nt
    buffer_load_dwordx4 v[142:145], v3, s[32:35], s56 offen nt
    buffer_load_dwordx4 v[146:149], v4, s[32:35], s56 offen nt
    s_barrier
    s_setprio 3
    s_mov_b32 s40, s28
    s_mov_b32 s41, s29
    s_waitcnt lgkmcnt(0)
    s_mul_i32 s60, s60, 0x9E3779B1
    s_add_u32 s60, s60, 0x7F4A7C1D
    s_and_b32 s60, s60, 0xfffffff0
    s_getreg_b32 s61, hwreg(HW_REG_XCC_ID, 0, 3)
    s_or_b32 s61, s61, s60
    s_sub_u32 s0, s61, s0
    s_atomic_add s0, s[28:29], s46
    v_mov_b32 v150, s4
    v_mov_b32 v151, s6
    v_mov_b32 v152, s8
    v_mov_b32 v153, s10
    v_mov_b32 v154, s12
    v_mov_b32 v155, s14
    v_mov_b32 v156, s16
    v_mov_b32 v157, s18
    v_mov_b32 v158, s20
    v_mov_b32 v159, s22
    v_mov_b32 v160, s24
    v_mov_b32 v161, s26
    v_mov_b32 v162, s64
    v_mov_b32 v163, s66
    v_mov_b32 v164, s68
    v_mov_b32 v165, s70
    v_mov_b32 v166, s72
    v_mov_b32 v167, s74
    s_mov_b32 exec_lo, 0
    v_mov_b32 v150, s5
    v_mov_b32 v151, s7
    v_mov_b32 v152, s9
    v_mov_b32 v153, s11
    v_mov_b32 v154, s13
    v_mov_b32 v155, s15
    v_mov_b32 v156, s17
    v_mov_b32 v157, s19
    v_mov_b32 v158, s21
    v_mov_b32 v159, s23
    v_mov_b32 v160, s25
    v_mov_b32 v161, s27
    v_mov_b32 v162, s65
    v_mov_b32 v163, s67
    v_mov_b32 v164, s69
    v_mov_b32 v165, s71
    v_mov_b32 v166, s73
    v_mov_b32 v167, s75
    s_mov_b64 exec, -1
L_dot:
    s_mov_b32 s50, 0x05040100
    s_mov_b32 s51, 0x07060302
    s_waitcnt vmcnt(34)
    v_perm_b32 v4, v10, v6, s50
    v_perm_b32 v5, v10, v6, s51
    v_dot2_f32_bf16 v6, v4, v150, 0
    v_dot2_f32_bf16 v10, v5, v150, 0
    v_perm_b32 v1, v11, v7, s50
    v_perm_b32 v2, v11, v7, s51
    v_dot2_f32_bf16 v7, v1, v150, 0
    v_dot2_f32_bf16 v11, v2, v150, 0
    v_perm_b32 v4, v12, v8, s50
    v_perm_b32 v5, v12, v8, s51
    v_dot2_f32_bf16 v8, v4, v150, 0
    v_dot2_f32_bf16 v12, v5, v150, 0
    v_perm_b32 v1, v13, v9, s50
    v_perm_b32 v2, v13, v9, s51
    v_dot2_f32_bf16 v9, v1, v150, 0
    v_dot2_f32_bf16 v13, v2, v150, 0
    s_waitcnt vmcnt(32)
    v_perm_b32 v4, v18, v14, s50
    v_perm_b32 v5, v18, v14, s51
    v_dot2c_f32_bf16 v6, v4, v151
    v_dot2c_f32_bf16 v10, v5, v151
    v_perm_b32 v1, v19, v15, s50
    v_perm_b32 v2, v19, v15, s51
    v_dot2c_f32_bf16 v7, v1, v151
    v_dot2c_f32_bf16 v11, v2, v151
    v_perm_b32 v4, v20, v16, s50
    v_perm_b32 v5, v20, v16, s51
    v_dot2c_f32_bf16 v8, v4, v151
    v_dot2c_f32_bf16 v12, v5, v151
    v_perm_b32 v1, v21, v17, s50
    v_perm_b32 v2, v21, v17, s51
    v_dot2c_f32_bf16 v9, v1, v151
    v_dot2c_f32_bf16 v13, v2, v151
    s_waitcnt vmcnt(30)
    v_perm_b32 v4, v26, v22, s50
    v_perm_b32 v5, v26, v22, s51
    v_dot2c_f32_bf16 v6, v4, v152
    v_dot2c_f32_bf16 v10, v5, v152
    v_perm_b32 v1, v27, v23, s50
    v_perm_b32 v2, v27, v23, s51
    v_dot2c_f32_bf16 v7, v1, v152
    v_dot2c_f32_bf16 v11, v2, v152
    v_perm_b32 v4, v28, v24, s50
    v_perm_b32 v5, v28, v24, s51
    v_dot2c_f32_bf16 v8, v4, v152
    v_dot2c_f32_bf16 v12, v5, v152
    v_perm_b32 v1, v29, v25, s50
    v_perm_b32 v2, v29, v25, s51
    v_dot2c_f32_bf16 v9, v1, v152
    v_dot2c_f32_bf16 v13, v2, v152
    s_waitcnt vmcnt(28)
    v_perm_b32 v4, v34, v30, s50
    v_perm_b32 v5, v34, v30, s51
    v_dot2c_f32_bf16 v6, v4, v153
    v_dot2c_f32_bf16 v10, v5, v153
    v_perm_b32 v1, v35, v31, s50
    v_perm_b32 v2, v35, v31, s51
    v_dot2c_f32_bf16 v7, v1, v153
    v_dot2c_f32_bf16 v11, v2, v153
    v_perm_b32 v4, v36, v32, s50
    v_perm_b32 v5, v36, v32, s51
    v_dot2c_f32_bf16 v8, v4, v153
    v_dot2c_f32_bf16 v12, v5, v153
    v_perm_b32 v1, v37, v33, s50
    v_perm_b32 v2, v37, v33, s51
    v_dot2c_f32_bf16 v9, v1, v153
    v_dot2c_f32_bf16 v13, v2, v153
    s_waitcnt vmcnt(26)
    v_perm_b32 v4, v42, v38, s50
    v_perm_b32 v5, v42, v38, s51
    v_dot2c_f32_bf16 v6, v4, v154
    v_dot2c_f32_bf16 v10, v5, v154
    v_perm_b32 v1, v43, v39, s50
    v_perm_b32 v2, v43, v39, s51
    v_dot2c_f32_bf16 v7, v1, v154
    v_dot2c_f32_bf16 v11, v2, v154
    v_perm_b32 v4, v44, v40, s50
    v_perm_b32 v5, v44, v40, s51
    v_dot2c_f32_bf16 v8, v4, v154
    v_dot2c_f32_bf16 v12, v5, v154
    v_perm_b32 v1, v45, v41, s50
    v_perm_b32 v2, v45, v41, s51
    v_dot2c_f32_bf16 v9, v1, v154
    v_dot2c_f32_bf16 v13, v2, v154
    s_waitcnt vmcnt(24)
    v_perm_b32 v4, v50, v46, s50
    v_perm_b32 v5, v50, v46, s51
    v_dot2c_f32_bf16 v6, v4, v155
    v_dot2c_f32_bf16 v10, v5, v155
    v_perm_b32 v1, v51, v47, s50
    v_perm_b32 v2, v51, v47, s51
    v_dot2c_f32_bf16 v7, v1, v155
    v_dot2c_f32_bf16 v11, v2, v155
    v_perm_b32 v4, v52, v48, s50
    v_perm_b32 v5, v52, v48, s51
    v_dot2c_f32_bf16 v8, v4, v155
    v_dot2c_f32_bf16 v12, v5, v155
    v_perm_b32 v1, v53, v49, s50
    v_perm_b32 v2, v53, v49, s51
    v_dot2c_f32_bf16 v9, v1, v155
    v_dot2c_f32_bf16 v13, v2, v155
    s_waitcnt vmcnt(22)
    v_perm_b32 v4, v58, v54, s50
    v_perm_b32 v5, v58, v54, s51
    v_dot2c_f32_bf16 v6, v4, v156
    v_dot2c_f32_bf16 v10, v5, v156
    v_perm_b32 v1, v59, v55, s50
    v_perm_b32 v2, v59, v55, s51
    v_dot2c_f32_bf16 v7, v1, v156
    v_dot2c_f32_bf16 v11, v2, v156
    v_perm_b32 v4, v60, v56, s50
    v_perm_b32 v5, v60, v56, s51
    v_dot2c_f32_bf16 v8, v4, v156
    v_dot2c_f32_bf16 v12, v5, v156
    v_perm_b32 v1, v61, v57, s50
    v_perm_b32 v2, v61, v57, s51
    v_dot2c_f32_bf16 v9, v1, v156
    v_dot2c_f32_bf16 v13, v2, v156
    s_waitcnt vmcnt(20)
    v_perm_b32 v4, v66, v62, s50
    v_perm_b32 v5, v66, v62, s51
    v_dot2c_f32_bf16 v6, v4, v157
    v_dot2c_f32_bf16 v10, v5, v157
    v_perm_b32 v1, v67, v63, s50
    v_perm_b32 v2, v67, v63, s51
    v_dot2c_f32_bf16 v7, v1, v157
    v_dot2c_f32_bf16 v11, v2, v157
    v_perm_b32 v4, v68, v64, s50
    v_perm_b32 v5, v68, v64, s51
    v_dot2c_f32_bf16 v8, v4, v157
    v_dot2c_f32_bf16 v12, v5, v157
    v_perm_b32 v1, v69, v65, s50
    v_perm_b32 v2, v69, v65, s51
    v_dot2c_f32_bf16 v9, v1, v157
    v_dot2c_f32_bf16 v13, v2, v157
    s_waitcnt vmcnt(18)
    v_perm_b32 v4, v74, v70, s50
    v_perm_b32 v5, v74, v70, s51
    v_dot2c_f32_bf16 v6, v4, v158
    v_dot2c_f32_bf16 v10, v5, v158
    v_perm_b32 v1, v75, v71, s50
    v_perm_b32 v2, v75, v71, s51
    v_dot2c_f32_bf16 v7, v1, v158
    v_dot2c_f32_bf16 v11, v2, v158
    v_perm_b32 v4, v76, v72, s50
    v_perm_b32 v5, v76, v72, s51
    v_dot2c_f32_bf16 v8, v4, v158
    v_dot2c_f32_bf16 v12, v5, v158
    v_perm_b32 v1, v77, v73, s50
    v_perm_b32 v2, v77, v73, s51
    v_dot2c_f32_bf16 v9, v1, v158
    v_dot2c_f32_bf16 v13, v2, v158
    s_cbranch_execz L_back
    s_load_dwordx16 s[4:19], s[28:29], s44 glc
L_dot2:
    s_waitcnt vmcnt(16)
    v_perm_b32 v4, v82, v78, s50
    v_perm_b32 v5, v82, v78, s51
    v_dot2c_f32_bf16 v6, v4, v159
    v_dot2c_f32_bf16 v10, v5, v159
    v_perm_b32 v1, v83, v79, s50
    v_perm_b32 v2, v83, v79, s51
    v_dot2c_f32_bf16 v7, v1, v159
    v_dot2c_f32_bf16 v11, v2, v159
    v_perm_b32 v4, v84, v80, s50
    v_perm_b32 v5, v84, v80, s51
    v_dot2c_f32_bf16 v8, v4, v159
    v_dot2c_f32_bf16 v12, v5, v159
    v_perm_b32 v1, v85, v81, s50
    v_perm_b32 v2, v85, v81, s51
    v_dot2c_f32_bf16 v9, v1, v159
    v_dot2c_f32_bf16 v13, v2, v159
    s_waitcnt vmcnt(14)
    v_perm_b32 v4, v90, v86, s50
    v_perm_b32 v5, v90, v86, s51
    v_dot2c_f32_bf16 v6, v4, v160
    v_dot2c_f32_bf16 v10, v5, v160
    v_perm_b32 v1, v91, v87, s50
    v_perm_b32 v2, v91, v87, s51
    v_dot2c_f32_bf16 v7, v1, v160
    v_dot2c_f32_bf16 v11, v2, v160
    v_perm_b32 v4, v92, v88, s50
    v_perm_b32 v5, v92, v88, s51
    v_dot2c_f32_bf16 v8, v4, v160
    v_dot2c_f32_bf16 v12, v5, v160
    v_perm_b32 v1, v93, v89, s50
    v_perm_b32 v2, v93, v89, s51
    v_dot2c_f32_bf16 v9, v1, v160
    v_dot2c_f32_bf16 v13, v2, v160
    s_waitcnt vmcnt(12)
    v_perm_b32 v4, v98, v94, s50
    v_perm_b32 v5, v98, v94, s51
    v_dot2c_f32_bf16 v6, v4, v161
    v_dot2c_f32_bf16 v10, v5, v161
    v_perm_b32 v1, v99, v95, s50
    v_perm_b32 v2, v99, v95, s51
    v_dot2c_f32_bf16 v7, v1, v161
    v_dot2c_f32_bf16 v11, v2, v161
    v_perm_b32 v4, v100, v96, s50
    v_perm_b32 v5, v100, v96, s51
    v_dot2c_f32_bf16 v8, v4, v161
    v_dot2c_f32_bf16 v12, v5, v161
    v_perm_b32 v1, v101, v97, s50
    v_perm_b32 v2, v101, v97, s51
    v_dot2c_f32_bf16 v9, v1, v161
    v_dot2c_f32_bf16 v13, v2, v161
    s_waitcnt vmcnt(10)
    v_perm_b32 v4, v106, v102, s50
    v_perm_b32 v5, v106, v102, s51
    v_dot2c_f32_bf16 v6, v4, v162
    v_dot2c_f32_bf16 v10, v5, v162
    v_perm_b32 v1, v107, v103, s50
    v_perm_b32 v2, v107, v103, s51
    v_dot2c_f32_bf16 v7, v1, v162
    v_dot2c_f32_bf16 v11, v2, v162
    v_perm_b32 v4, v108, v104, s50
    v_perm_b32 v5, v108, v104, s51
    v_dot2c_f32_bf16 v8, v4, v162
    v_dot2c_f32_bf16 v12, v5, v162
    v_perm_b32 v1, v109, v105, s50
    v_perm_b32 v2, v109, v105, s51
    v_dot2c_f32_bf16 v9, v1, v162
    v_dot2c_f32_bf16 v13, v2, v162
    s_waitcnt vmcnt(8)
    v_perm_b32 v4, v114, v110, s50
    v_perm_b32 v5, v114, v110, s51
    v_dot2c_f32_bf16 v6, v4, v163
    v_dot2c_f32_bf16 v10, v5, v163
    v_perm_b32 v1, v115, v111, s50
    v_perm_b32 v2, v115, v111, s51
    v_dot2c_f32_bf16 v7, v1, v163
    v_dot2c_f32_bf16 v11, v2, v163
    v_perm_b32 v4, v116, v112, s50
    v_perm_b32 v5, v116, v112, s51
    v_dot2c_f32_bf16 v8, v4, v163
    v_dot2c_f32_bf16 v12, v5, v163
    v_perm_b32 v1, v117, v113, s50
    v_perm_b32 v2, v117, v113, s51
    v_dot2c_f32_bf16 v9, v1, v163
    v_dot2c_f32_bf16 v13, v2, v163
    s_waitcnt vmcnt(6)
    v_perm_b32 v4, v122, v118, s50
    v_perm_b32 v5, v122, v118, s51
    v_dot2c_f32_bf16 v6, v4, v164
    v_dot2c_f32_bf16 v10, v5, v164
    v_perm_b32 v1, v123, v119, s50
    v_perm_b32 v2, v123, v119, s51
    v_dot2c_f32_bf16 v7, v1, v164
    v_dot2c_f32_bf16 v11, v2, v164
    v_perm_b32 v4, v124, v120, s50
    v_perm_b32 v5, v124, v120, s51
    v_dot2c_f32_bf16 v8, v4, v164
    v_dot2c_f32_bf16 v12, v5, v164
    v_perm_b32 v1, v125, v121, s50
    v_perm_b32 v2, v125, v121, s51
    v_dot2c_f32_bf16 v9, v1, v164
    v_dot2c_f32_bf16 v13, v2, v164
    s_waitcnt vmcnt(4)
    v_perm_b32 v4, v130, v126, s50
    v_perm_b32 v5, v130, v126, s51
    v_dot2c_f32_bf16 v6, v4, v165
    v_dot2c_f32_bf16 v10, v5, v165
    v_perm_b32 v1, v131, v127, s50
    v_perm_b32 v2, v131, v127, s51
    v_dot2c_f32_bf16 v7, v1, v165
    v_dot2c_f32_bf16 v11, v2, v165
    v_perm_b32 v4, v132, v128, s50
    v_perm_b32 v5, v132, v128, s51
    v_dot2c_f32_bf16 v8, v4, v165
    v_dot2c_f32_bf16 v12, v5, v165
    v_perm_b32 v1, v133, v129, s50
    v_perm_b32 v2, v133, v129, s51
    v_dot2c_f32_bf16 v9, v1, v165
    v_dot2c_f32_bf16 v13, v2, v165
    s_waitcnt vmcnt(2)
    v_perm_b32 v4, v138, v134, s50
    v_perm_b32 v5, v138, v134, s51
    v_dot2c_f32_bf16 v6, v4, v166
    v_dot2c_f32_bf16 v10, v5, v166
    v_perm_b32 v1, v139, v135, s50
    v_perm_b32 v2, v139, v135, s51
    v_dot2c_f32_bf16 v7, v1, v166
    v_dot2c_f32_bf16 v11, v2, v166
    v_perm_b32 v4, v140, v136, s50
    v_perm_b32 v5, v140, v136, s51
    v_dot2c_f32_bf16 v8, v4, v166
    v_dot2c_f32_bf16 v12, v5, v166
    v_perm_b32 v1, v141, v137, s50
    v_perm_b32 v2, v141, v137, s51
    v_dot2c_f32_bf16 v9, v1, v166
    v_dot2c_f32_bf16 v13, v2, v166
    s_waitcnt vmcnt(0)
    v_perm_b32 v4, v146, v142, s50
    v_perm_b32 v5, v146, v142, s51
    v_dot2c_f32_bf16 v6, v4, v167
    v_dot2c_f32_bf16 v10, v5, v167
    v_perm_b32 v1, v147, v143, s50
    v_perm_b32 v2, v147, v143, s51
    v_dot2c_f32_bf16 v7, v1, v167
    v_dot2c_f32_bf16 v11, v2, v167
    v_perm_b32 v4, v148, v144, s50
    v_perm_b32 v5, v148, v144, s51
    v_dot2c_f32_bf16 v8, v4, v167
    v_dot2c_f32_bf16 v12, v5, v167
    v_perm_b32 v1, v149, v145, s50
    v_perm_b32 v2, v149, v145, s51
    v_dot2c_f32_bf16 v9, v1, v167
    v_dot2c_f32_bf16 v13, v2, v167
    s_mov_b32 s62, 0x20000
    s_cbranch_execz L_prx
L_pr:
    s_waitcnt lgkmcnt(0)
    s_xor_b32 s4, s4, s61
    s_xor_b32 s5, s5, s61
    s_or_b32 s4, s4, s5
    s_xor_b32 s6, s6, s61
    s_or_b32 s4, s4, s6
    s_xor_b32 s7, s7, s61
    s_or_b32 s4, s4, s7
    s_xor_b32 s8, s8, s61
    s_or_b32 s4, s4, s8
    s_xor_b32 s9, s9, s61
    s_or_b32 s4, s4, s9
    s_xor_b32 s10, s10, s61
    s_or_b32 s4, s4, s10
    s_xor_b32 s11, s11, s61
    s_or_b32 s4, s4, s11
    s_xor_b32 s12, s12, s61
    s_or_b32 s4, s4, s12
    s_xor_b32 s13, s13, s61
    s_or_b32 s4, s4, s13
    s_xor_b32 s14, s14, s61
    s_or_b32 s4, s4, s14
    s_xor_b32 s15, s15, s61
    s_or_b32 s4, s4, s15
    s_xor_b32 s16, s16, s61
    s_or_b32 s4, s4, s16
    s_xor_b32 s17, s17, s61
    s_or_b32 s4, s4, s17
    s_xor_b32 s18, s18, s61
    s_or_b32 s4, s4, s18
    s_xor_b32 s19, s19, s61
    s_or_b32 s4, s4, s19
    s_cmp_le_u32 s4, 15
    s_cbranch_scc1 L_prx
    s_load_dwordx16 s[4:19], s[28:29], s44 glc
    s_sub_u32 s62, s62, 1
    s_cbranch_scc0 L_pr
    s_waitcnt lgkmcnt(0)
    s_mov_b32 s4, 1
L_prx:
    s_and_b32 s4, s4, -9
    s_cselect_b32 s61, 0, 1
    v_permlane32_swap_b32 v6, v8
    v_permlane32_swap_b32 v10, v12
    v_permlane32_swap_b32 v7, v9
    v_permlane32_swap_b32 v11, v13
    s_lshr_b32 s5, s60, 12
    s_xor_b32 s5, s5, s60
    v_bfe_u32 v20, s5, 0, 8
    v_bfe_u32 v21, s5, 8, 8
    v_bfe_u32 v22, s5, 16, 8
    v_bfe_u32 v23, s5, 24, 8
    s_mov_b32 s5, 0xffffff00
    v_add_f32 v16, v6, v8
    v_add_f32 v17, v10, v12
    v_add_f32 v18, v7, v9
    v_add_f32 v19, v11, v13
    v_and_or_b32 v16, v16, s5, v20
    v_and_or_b32 v17, v17, s5, v21
    v_and_or_b32 v18, v18, s5, v22
    v_and_or_b32 v19, v19, s5, v23
    v_lshlrev_b32 v3, 4, v0
    s_lshl_b32 s48, s30, 14
    s_add_u32 s48, s48, 4096
    s_lshl_b32 s49, s31, 10
    s_add_u32 s49, s49, s48
    s_cbranch_execz L_back
    s_cmp_eq_u32 s61, 0
    s_cbranch_scc1 L_qslow
    buffer_store_dwordx4 v[16:19], v3, s[40:43], s49 offen
    s_branch L_qst
L_qslow:
    buffer_store_dwordx4 v[16:19], v3, s[40:43], s49 offen sc1
L_qst:
    s_mov_b32 s1, 8
    s_atomic_add s1, s[28:29], s46
L_gat:
    s_add_u32 s49, s48, 4096
    s_add_u32 s50, s48, 8192
    s_add_u32 s51, s48, 12288
    s_add_u32 s52, s48, 16384
    s_add_u32 s53, s48, 20480
    s_add_u32 s54, s48, 24576
    s_add_u32 s55, s48, 28672
    v_mov_b32 v1, s60
    s_or_b32 s58, s60, 8
    s_mov_b32 s62, 0x20000
    s_cbranch_execz L_spx
    s_sleep 20
L_sp:
    s_load_dwordx16 s[4:19], s[28:29], s44 glc
    s_waitcnt lgkmcnt(0)
    s_xor_b32 s4, s4, s58
    s_xor_b32 s5, s5, s58
    s_or_b32 s4, s4, s5
    s_xor_b32 s6, s6, s58
    s_or_b32 s4, s4, s6
    s_xor_b32 s7, s7, s58
    s_or_b32 s4, s4, s7
    s_xor_b32 s8, s8, s58
    s_or_b32 s4, s4, s8
    s_xor_b32 s9, s9, s58
    s_or_b32 s4, s4, s9
    s_xor_b32 s10, s10, s58
    s_or_b32 s4, s4, s10
    s_xor_b32 s11, s11, s58
    s_or_b32 s4, s4, s11
    s_xor_b32 s12, s12, s58
    s_or_b32 s4, s4, s12
    s_xor_b32 s13, s13, s58
    s_or_b32 s4, s4, s13
    s_xor_b32 s14, s14, s58
    s_or_b32 s4, s4, s14
    s_xor_b32 s15, s15, s58
    s_or_b32 s4, s4, s15
    s_xor_b32 s16, s16, s58
    s_or_b32 s4, s4, s16
    s_xor_b32 s17, s17, s58
    s_or_b32 s4, s4, s17
    s_xor_b32 s18, s18, s58
    s_or_b32 s4, s4, s18
    s_xor_b32 s19, s19, s58
    s_or_b32 s4, s4, s19
    s_cmp_le_u32 s4, 7
    s_cbranch_scc1 L_spx
    s_sleep 8
    s_sub_u32 s62, s62, 1
    s_cbranch_scc0 L_sp
L_spx:
    s_mov_b32 s62, 0x8000
L_qp:
    s_cbranch_execz L_sk11
    buffer_load_dwordx4 v[24:27], v3, s[40:43], s48 offen offset:0 sc1
    buffer_load_dwordx4 v[28:31], v3, s[40:43], s48 offen offset:1024 sc1
    buffer_load_dwordx4 v[32:35], v3, s[40:43], s48 offen offset:2048 sc1
    buffer_load_dwordx4 v[36:39], v3, s[40:43], s48 offen offset:3072 sc1
    buffer_load_dwordx4 v[40:43], v3, s[40:43], s49 offen offset:0 sc1
    buffer_load_dwordx4 v[44:47], v3, s[40:43], s49 offen offset:1024 sc1
    buffer_load_dwordx4 v[48:51], v3, s[40:43], s49 offen offset:2048 sc1
    buffer_load_dwordx4 v[52:55], v3, s[40:43], s49 offen offset:3072 sc1
    buffer_load_dwordx4 v[56:59], v3, s[40:43], s50 offen offset:0 sc1
    buffer_load_dwordx4 v[60:63], v3, s[40:43], s50 offen offset:1024 sc1
    buffer_load_dwordx4 v[64:67], v3, s[40:43], s50 offen offset:2048 sc1
    buffer_load_dwordx4 v[68:71], v3, s[40:43], s50 offen offset:3072 sc1
    buffer_load_dwordx4 v[72:75], v3, s[40:43], s51 offen offset:0 sc1
    buffer_load_dwordx4 v[76:79], v3, s[40:43], s51 offen offset:1024 sc1
    buffer_load_dwordx4 v[80:83], v3, s[40:43], s51 offen offset:2048 sc1
    buffer_load_dwordx4 v[84:87], v3, s[40:43], s51 offen offset:3072 sc1
L_sk11:
    s_waitcnt vmcnt(12)
    v_xor_b32 v24, v20, v24
    v_xor_b32 v25, v21, v25
    v_xor_b32 v26, v22, v26
    v_xor_b32 v27, v23, v27
    v_or_b32 v6, v24, v25
    v_or_b32 v7, v26, v27
    v_xor_b32 v28, v20, v28
    v_xor_b32 v29, v21, v29
    v_xor_b32 v30, v22, v30
    v_xor_b32 v31, v23, v31
    v_or3_b32 v6, v6, v28, v29
    v_or3_b32 v7, v7, v30, v31
    v_add_f32 v24, v24, v28
    v_add_f32 v25, v25, v29
    v_add_f32 v26, v26, v30
    v_add_f32 v27, v27, v31
    v_xor_b32 v32, v20, v32
    v_xor_b32 v33, v21, v33
    v_xor_b32 v34, v22, v34
    v_xor_b32 v35, v23, v35
    v_or3_b32 v6, v6, v32, v33
    v_or3_b32 v7, v7, v34, v35
    v_add_f32 v24, v24, v32
    v_add_f32 v25, v25, v33
    v_add_f32 v26, v26, v34
    v_add_f32 v27, v27, v35
    v_xor_b32 v36, v20, v36
    v_xor_b32 v37, v21, v37
    v_xor_b32 v38, v22, v38
    v_xor_b32 v39, v23, v39
    v_or3_b32 v6, v6, v36, v37
    v_or3_b32 v7, v7, v38, v39
    v_add_f32 v24, v24, v36
    v_add_f32 v25, v25, v37
    v_add_f32 v26, v26, v38
    v_add_f32 v27, v27, v39
    s_waitcnt vmcnt(8)
    v_xor_b32 v40, v20, v40
    v_xor_b32 v41, v21, v41
    v_xor_b32 v42, v22, v42
    v_xor_b32 v43, v23, v43
    v_or3_b32 v6, v6, v40, v41
    v_or3_b32 v7, v7, v42, v43
    v_add_f32 v24, v24, v40
    v_add_f32 v25, v25, v41
    v_add_f32 v26, v26, v42
    v_add_f32 v27, v27, v43
    v_xor_b32 v44, v20, v44
    v_xor_b32 v45, v21, v45
    v_xor_b32 v46, v22, v46
    v_xor_b32 v47, v23, v47
    v_or3_b32 v6, v6, v44, v45
    v_or3_b32 v7, v7, v46, v47
    v_add_f32 v24, v24, v44
    v_add_f32 v25, v25, v45
    v_add_f32 v26, v26, v46
    v_add_f32 v27, v27, v47
    v_xor_b32 v48, v20, v48
    v_xor_b32 v49, v21, v49
    v_xor_b32 v50, v22, v50
    v_xor_b32 v51, v23, v51
    v_or3_b32 v6, v6, v48, v49
    v_or3_b32 v7, v7, v50, v51
    v_add_f32 v24, v24, v48
    v_add_f32 v25, v25, v49
    v_add_f32 v26, v26, v50
    v_add_f32 v27, v27, v51
    v_xor_b32 v52, v20, v52
    v_xor_b32 v53, v21, v53
    v_xor_b32 v54, v22, v54
    v_xor_b32 v55, v23, v55
    v_or3_b32 v6, v6, v52, v53
    v_or3_b32 v7, v7, v54, v55
    v_add_f32 v24, v24, v52
    v_add_f32 v25, v25, v53
    v_add_f32 v26, v26, v54
    v_add_f32 v27, v27, v55
    s_waitcnt vmcnt(4)
    v_xor_b32 v56, v20, v56
    v_xor_b32 v57, v21, v57
    v_xor_b32 v58, v22, v58
    v_xor_b32 v59, v23, v59
    v_or3_b32 v6, v6, v56, v57
    v_or3_b32 v7, v7, v58, v59
    v_xor_b32 v60, v20, v60
    v_xor_b32 v61, v21, v61
    v_xor_b32 v62, v22, v62
    v_xor_b32 v63, v23, v63
    v_or3_b32 v6, v6, v60, v61
    v_or3_b32 v7, v7, v62, v63
    v_add_f32 v56, v56, v60
    v_add_f32 v57, v57, v61
    v_add_f32 v58, v58, v62
    v_add_f32 v59, v59, v63
    v_xor_b32 v64, v20, v64
    v_xor_b32 v65, v21, v65
    v_xor_b32 v66, v22, v66
    v_xor_b32 v67, v23, v67
    v_or3_b32 v6, v6, v64, v65
    v_or3_b32 v7, v7, v66, v67
    v_add_f32 v56, v56, v64
    v_add_f32 v57, v57, v65
    v_add_f32 v58, v58, v66
    v_add_f32 v59, v59, v67
    v_xor_b32 v68, v20, v68
    v_xor_b32 v69, v21, v69
    v_xor_b32 v70, v22, v70
    v_xor_b32 v71, v23, v71
    v_or3_b32 v6, v6, v68, v69
    v_or3_b32 v7, v7, v70, v71
    v_add_f32 v56, v56, v68
    v_add_f32 v57, v57, v69
    v_add_f32 v58, v58, v70
    v_add_f32 v59, v59, v71
    s_waitcnt vmcnt(0)
    v_xor_b32 v72, v20, v72
    v_xor_b32 v73, v21, v73
    v_xor_b32 v74, v22, v74
    v_xor_b32 v75, v23, v75
    v_or3_b32 v6, v6, v72, v73
    v_or3_b32 v7, v7, v74, v75
    v_add_f32 v56, v56, v72
    v_add_f32 v57, v57, v73
    v_add_f32 v58, v58, v74
    v_add_f32 v59, v59, v75
    v_xor_b32 v76, v20, v76
    v_xor_b32 v77, v21, v77
    v_xor_b32 v78, v22, v78
    v_xor_b32 v79, v23, v79
    v_or3_b32 v6, v6, v76, v77
    v_or3_b32 v7, v7, v78, v79
    v_add_f32 v56, v56, v76
    v_add_f32 v57, v57, v77
    v_add_f32 v58, v58, v78
    v_add_f32 v59, v59, v79
    v_xor_b32 v80, v20, v80
    v_xor_b32 v81, v21, v81
    v_xor_b32 v82, v22, v82
    v_xor_b32 v83, v23, v83
    v_or3_b32 v6, v6, v80, v81
    v_or3_b32 v7, v7, v82, v83
    v_add_f32 v56, v56, v80
    v_add_f32 v57, v57, v81
    v_add_f32 v58, v58, v82
    v_add_f32 v59, v59, v83
    v_xor_b32 v84, v20, v84
    v_xor_b32 v85, v21, v85
    v_xor_b32 v86, v22, v86
    v_xor_b32 v87, v23, v87
    v_or3_b32 v6, v6, v84, v85
    v_or3_b32 v7, v7, v86, v87
    v_add_f32 v56, v56, v84
    v_add_f32 v57, v57, v85
    v_add_f32 v58, v58, v86
    v_add_f32 v59, v59, v87
    v_or_b32 v6, v6, v7
    v_and_b32 v6, 0xff, v6
    v_cmp_ne_u32 vcc, 0, v6
    s_cbranch_vccz L_qpx
    s_sub_u32 s62, s62, 1
    s_cbranch_scc0 L_qp
L_qpx:
    v_cvt_pk_bf16_f32 v24, v24, v25
    v_cvt_pk_bf16_f32 v25, v26, v27
    v_cvt_pk_bf16_f32 v88, v56, v57
    v_cvt_pk_bf16_f32 v89, v58, v59
    v_and_b32 v4, 31, v0
    v_lshlrev_b32 v4, 4, v4
    v_lshrrev_b32 v5, 5, v0
    v_lshl_add_u32 v4, v5, 3, v4
    v_mov_b32 v6, v1
    v_mov_b32 v7, s61
    v_mov_b32 v2, 0
    v_mov_b32 v32, 1
    ds_write_b64 v4, v[24:25] offset:512
    ds_write_b64 v4, v[88:89] offset:1024
    ds_write_b64 v2, v[6:7] offset:8
    ds_write_b32 v2, v32 offset:0
    s_cbranch_execz L_back
    s_lshl_b32 s56, s30, 5
    s_lshr_b32 s49, s31, 3
    s_add_u32 s56, s56, s49
    s_mul_i32 s57, s56, 1152
    s_add_u32 s57, s57, 278528
    s_and_b32 s56, s31, 7
    s_lshl_b32 s59, s56, 7
    s_add_u32 s59, s59, s57
    s_mov_b32 s52, s59
    s_add_u32 s53, s59, 18432
    s_lshr_b32 s56, s56, 2
    s_lshl_b32 s56, s56, 8
    s_lshl_b32 s57, s49, 9
    s_add_u32 s57, s57, s56
    s_lshl_b32 s56, s30, 10
    s_add_u32 s57, s57, s56
    s_add_u32 s57, s57, 1478656
    v_lshrrev_b32 v34, 3, v0
    v_mul_u32_u24 v5, 2304, v34
    v_and_b32 v4, 7, v0
    v_lshl_add_u32 v5, v4, 4, v5
    v_and_b32 v33, 1, v0
    v_lshl_add_u32 v4, v33, 3, v34
    v_lshlrev_b32 v4, 4, v4
    v_lshlrev_b32 v33, 5, v33
    v_lshrrev_b32 v34, 5, v0
    v_lshl_add_u32 v33, v34, 4, v33
    v_and_b32 v34, 6, v0
    v_lshl_add_u32 v33, v34, 1, v33
    s_cmp_lt_u32 s31, 8
    s_cselect_b32 s58, 18, 21
    v_mov_b32 v35, 1
    s_mov_b64 exec, 0
L_h1go:
    s_mov_b32 s62, 0x80000
    s_cbranch_execz L_lpx13
L_lp12:
    ds_read_b32 v8, v2 offset:16
    s_waitcnt lgkmcnt(0)
    v_cmp_le_u32 vcc, s58, v8
    s_cbranch_vccnz L_lpx13
    s_sleep 1
    s_sub_u32 s62, s62, 1
    s_cbranch_scc0 L_lp12
L_lpx13:
    s_mov_b32 s62, 0x8000
    s_mov_b64 s[66:67], exec
L_mp14:
    s_cbranch_execz L_sk16
    buffer_load_dwordx4 v[24:27], v4, s[40:43], s57 offen sc1
    buffer_load_dwordx4 v[8:11], v5, s[40:43], s52 offen sc1
    buffer_load_dwordx4 v[12:15], v5, s[40:43], s53 offen sc1
L_sk16:
    s_waitcnt vmcnt(0)
    v_xor_b32 v28, v1, v9
    v_xor_b32 v29, v1, v11
    v_bitop3_b32 v28, v28, v1, v13 bitop3:0xf6
    v_bitop3_b32 v29, v29, v1, v15 bitop3:0xf6
    v_bitop3_b32 v28, v28, v1, v25 bitop3:0xf6
    v_bitop3_b32 v29, v29, v1, v27 bitop3:0xf6
    v_or_b32 v28, v28, v29
    v_cmpx_ne_u32 vcc, 0, v28
    s_cbranch_vccz L_mpx15
    s_sub_u32 s62, s62, 1
    s_cbranch_scc0 L_mp14
L_mpx15:
    s_mov_b64 exec, s[66:67]
    s_nop 2
    v_max_f32_dpp v28, v24, v24 quad_perm:[1,0,3,2] row_mask:0xf bank_mask:0xf
    v_and_b32 v9, 0xffff0000, v8
    v_and_b32 v11, 0xffff0000, v10
    v_max_f32_dpp v28, v28, v28 row_ror:8 row_mask:0xf bank_mask:0xf
    v_mov_b32 v29, v28
    v_and_b32 v13, 0xffff0000, v12
    v_and_b32 v15, 0xffff0000, v14
    v_permlane32_swap_b32 v28, v29
    v_max_f32 v28, v28, v29
    v_mov_b32 v29, v28
    v_lshlrev_b32 v8, 16, v8
    v_lshlrev_b32 v10, 16, v10
    v_permlane16_swap_b32 v28, v29
    v_max_f32 v28, v28, v29
    v_sub_f32 v24, v24, v28
    v_exp_f32 v24, v24
    v_lshlrev_b32 v12, 16, v12
    v_lshlrev_b32 v14, 16, v14
    v_mul_f32 v26, v26, v24
    v_mul_f32_dpp v8, v24, v8 quad_perm:[0,0,0,0] row_mask:0xf bank_mask:0xf
    v_mul_f32_dpp v9, v24, v9 quad_perm:[0,0,0,0] row_mask:0xf bank_mask:0xf
    v_mul_f32_dpp v10, v24, v10 quad_perm:[0,0,0,0] row_mask:0xf bank_mask:0xf
    v_mul_f32_dpp v11, v24, v11 quad_perm:[0,0,0,0] row_mask:0xf bank_mask:0xf
    v_add_f32_dpp v26, v26, v26 quad_perm:[1,0,3,2] row_mask:0xf bank_mask:0xf
    v_fmac_f32_dpp v8, v24, v12 quad_perm:[1,1,1,1] row_mask:0xf bank_mask:0xf
    v_fmac_f32_dpp v9, v24, v13 quad_perm:[1,1,1,1] row_mask:0xf bank_mask:0xf
    v_fmac_f32_dpp v10, v24, v14 quad_perm:[1,1,1,1] row_mask:0xf bank_mask:0xf
    v_fmac_f32_dpp v11, v24, v15 quad_perm:[1,1,1,1] row_mask:0xf bank_mask:0xf
    v_mov_b32 v27, v26
    v_permlane32_swap_b32 v8, v10
    v_permlane32_swap_b32 v9, v11
    v_permlane32_swap_b32 v26, v27
    v_add_f32 v8, v8, v10
    v_add_f32 v9, v9, v11
    v_add_f32 v26, v26, v27
    v_mov_b32 v27, v26
    v_permlane16_swap_b32 v8, v9
    s_nop 0
    v_permlane16_swap_b32 v26, v27
    v_add_f32 v8, v8, v9
    v_add_f32 v26, v26, v27
    s_nop 1
    v_add_f32_dpp v26, v26, v26 row_ror:8 row_mask:0xf bank_mask:0xf
    v_add_f32_dpp v8, v8, v8 row_ror:8 row_mask:0xf bank_mask:0xf
    v_rcp_f32 v26, v26
    s_nop 0
    v_mul_f32 v8, v8, v26
    v_mov_b32 v9, v8
    s_nop 1
    v_permlane16_swap_b32 v8, v9
    v_cvt_pk_bf16_f32 v8, v8, v9
    ds_write_b32 v33, v8 offset:128
    s_waitcnt lgkmcnt(0)
    s_cbranch_execz L_h1dry
    s_barrier
    s_branch L_fin
L_h1dry:
    s_mov_b64 exec, -1
    s_branch L_h1go
L_wo:
    s_setprio 0
    s_sub_u32 s58, s3, 1
    s_cmp_lt_u32 s31, 8
    s_cselect_b32 s32, s12, s22
    s_cselect_b32 s33, s13, s23
    s_mov_b32 s34, 4718592
    s_lshl_b32 s48, s30, 8
    s_bfe_u32 s49, s31, 0x10002
    s_lshl_b32 s49, s49, 7
    s_add_u32 s48, s48, s49
    s_and_b32 s49, s31, 1
    s_lshl_b32 s49, s49, 6
    s_add_u32 s48, s48, s49
    s_and_b32 s49, s31, 2
    s_lshl_b32 s49, s49, 1
    s_add_u32 s48, s48, s49
    s_mul_i32 s52, s48, 1152
    s_lshl_b32 s49, s58, 7
    s_add_u32 s52, s52, s49
    s_add_u32 s53, s52, 18432
    s_add_u32 s54, s52, 36864
    s_add_u32 s55, s52, 55296
    v_bfe_u32 v8, v0, 1, 1
    v_mul_u32_u24 v8, 0x0202, v8
    v_add_u32 v8, 0x0100, v8
    v_xor_b32 v8, 0x0c0c, v8
    v_and_b32 v9, 1, v0
    v_lshlrev_b32 v9, 4, v9
    v_lshlrev_b32 v8, v9, v8
    v_xor_b32 v8, 0x0c0c0c0c, v8
    v_bfe_u32 v9, v0, 2, 2
    v_mov_b32 v10, 0x0c0c0c0c
    v_cmp_eq_u32 vcc, 0, v9
    s_nop 1
    v_cndmask_b32 v4, v10, v8, vcc
    v_cmp_eq_u32 vcc, 1, v9
    s_nop 1
    v_cndmask_b32 v5, v10, v8, vcc
    v_cmp_eq_u32 vcc, 2, v9
    s_nop 1
    v_cndmask_b32 v6, v10, v8, vcc
    v_cmp_eq_u32 vcc, 3, v9
    s_nop 1
    v_cndmask_b32 v7, v10, v8, vcc
    v_and_b32 v3, 48, v0
    s_lshl_b32 s48, s30, 3
    s_and_b32 s49, s31, 7
    s_add_u32 s48, s48, s49
    s_lshr_b32 s49, s31, 3
    s_lshl_b32 s56, s49, 7
    s_add_u32 s56, s56, s48
    s_mul_i32 s56, s56, 2304
    s_lshl_b32 s57, s58, 8
    s_add_u32 s56, s56, s57
    s_add_u32 s56, s56, 884736
    v_and_b32 v9, 7, v0
    v_lshrrev_b32 v10, 1, v3
    v_lshl_add_u32 v9, v9, 5, v10
    v_bfe_u32 v10, v0, 3, 1
    v_mul_u32_u24 v11, 1507328, v10
    v_add_u32 v9, v9, v11
    v_lshrrev_b32 v8, 5, v0
    v_lshlrev_b32 v8, 3, v8
    v_bfe_u32 v10, v0, 3, 2
    v_add_u32 v8, v8, v10
    v_mul_u32_u24 v8, 1152, v8
    v_and_b32 v10, 7, v0
    v_lshl_add_u32 v8, v10, 4, v8
    v_mov_b32 v53, v1
    v_mov_b32 v77, v1
    s_lshr_b32 s68, s2, 5
    s_lshl_b32 s68, s68, 3
    s_and_b32 s49, s2, 7
    s_add_u32 s68, s68, s49
    s_lshl_b32 s57, s68, 2
    s_bfe_u32 s49, s2, 0x20003
    s_add_u32 s57, s57, s49
    v_lshrrev_b32 v54, 1, v0
    v_and_b32 v55, 1, v0
    v_lshlrev_b32 v55, 4, v55
    s_cmp_ge_u32 s68, 18
    s_cselect_b32 s48, 292608, 0
    s_lshl_b32 s49, s57, 5
    s_add_u32 s48, s48, s49
    v_mul_u32_u24 v54, 2304, v54
    v_add_u32 v54, v54, v55
    s_add_u32 s48, s48, 884736
    s_add_u32 s49, s48, 73728
    s_add_u32 s50, s48, 147456
    s_add_u32 s51, s48, 221184
    s_mov_b32 s44, s24
    s_mov_b32 s45, s25
    s_mov_b32 s46, 2304
    s_mov_b32 s47, 0x20000
    s_lshl_b32 s57, s57, 4
    v_lshrrev_b32 v55, 1, v55
    v_lshrrev_b32 v56, 5, v0
    v_lshl_add_u32 v55, v56, 2, v55
    v_and_b32 v56, 30, v0
    v_lshl_add_u32 v55, v56, 12, v55
    s_mov_b32 s70, 0x3f80
    s_mov_b32 s71, 0x3f800000
    s_cmp_lt_u32 s3, 11
    s_cbranch_scc1 L_wogo
    s_mov_b64 exec, 0
L_wogo:
    s_bitcmp1_b32 0x16, s3
    s_cselect_b32 s59, 20, 21
    s_mov_b32 s62, 0x80000
    s_cbranch_execz L_lpx18
L_lp17:
    ds_read_b32 v10, v2 offset:16
    s_waitcnt lgkmcnt(0)
    v_cmp_le_u32 vcc, s59, v10
    s_cbranch_vccnz L_lpx18
    s_sleep 1
    s_sub_u32 s62, s62, 1
    s_cbranch_scc0 L_lp17
L_lpx18:
    s_bitcmp1_b32 0x808, s3
    s_cbranch_execz L_sk19
    buffer_load_dwordx4 v[12:15], v8, s[32:35], s52 offen nt
    buffer_load_dwordx4 v[16:19], v8, s[32:35], s53 offen nt
    buffer_load_dwordx4 v[20:23], v8, s[32:35], s54 offen nt
    buffer_load_dwordx4 v[24:27], v8, s[32:35], s55 offen nt
    s_cbranch_scc0 L_op1
L_sk19:
    s_cbranch_execz L_sk20
    buffer_load_dwordx4 v[56:59], v8, s[32:35], s52 offen offset:768 nt
    buffer_load_dwordx4 v[60:63], v8, s[32:35], s53 offen offset:768 nt
    buffer_load_dwordx4 v[64:67], v8, s[32:35], s54 offen offset:768 nt
    buffer_load_dwordx4 v[68:71], v8, s[32:35], s55 offen offset:768 nt
L_sk20:
L_op1:
    s_cbranch_execz L_sk21
    s_barrier
L_sk21:
    ds_read_b128 v[28:31], v3 offset:128
    s_waitcnt lgkmcnt(0)
    v_perm_b32 v32, v28, v28, v4
    v_perm_b32 v33, v28, v28, v5
    v_perm_b32 v34, v28, v28, v6
    v_perm_b32 v35, v28, v28, v7
    v_perm_b32 v36, v29, v29, v4
    v_perm_b32 v37, v29, v29, v5
    v_perm_b32 v38, v29, v29, v6
    v_perm_b32 v39, v29, v29, v7
    s_waitcnt vmcnt(0)
    v_mfma_f32_16x16x32_bf16 v[48:51], v[32:35], v[12:15], 0
    v_perm_b32 v40, v30, v30, v4
    v_perm_b32 v41, v30, v30, v5
    v_perm_b32 v42, v30, v30, v6
    v_perm_b32 v43, v30, v30, v7
    v_mfma_f32_16x16x32_bf16 v[48:51], v[36:39], v[16:19], v[48:51]
    v_perm_b32 v44, v31, v31, v4
    v_perm_b32 v45, v31, v31, v5
    v_perm_b32 v46, v31, v31, v6
    v_perm_b32 v47, v31, v31, v7
    v_mfma_f32_16x16x32_bf16 v[48:51], v[40:43], v[20:23], v[48:51]
    s_nop 0
    v_mfma_f32_16x16x32_bf16 v[48:51], v[44:47], v[24:27], v[48:51]
    s_cbranch_scc0 L_op2
    v_mfma_f32_16x16x32_bf16 v[72:75], v[32:35], v[56:59], 0
    v_mfma_f32_16x16x32_bf16 v[72:75], v[36:39], v[60:63], v[72:75]
    v_mfma_f32_16x16x32_bf16 v[72:75], v[40:43], v[64:67], v[72:75]
    v_mfma_f32_16x16x32_bf16 v[72:75], v[44:47], v[68:71], v[72:75]
L_op2:
    s_nop 6
    v_add_f32_dpp v48, v50, v48 row_ror:8 row_mask:0xf bank_mask:0xf
    v_add_f32_dpp v49, v51, v49 row_ror:8 row_mask:0xf bank_mask:0xf
    v_cvt_pk_bf16_f32 v52, v48, v49
    s_cbranch_execz L_sk22
    buffer_store_dwordx2 v[52:53], v9, s[40:43], s56 offen sc1
L_sk22:
    s_cbranch_scc0 L_fin
    v_add_f32_dpp v72, v74, v72 row_ror:8 row_mask:0xf bank_mask:0xf
    v_add_f32_dpp v73, v75, v73 row_ror:8 row_mask:0xf bank_mask:0xf
    v_cvt_pk_bf16_f32 v76, v72, v73
    s_cbranch_execz L_red
    buffer_store_dwordx2 v[76:77], v9, s[40:43], s56 offen offset:1536 sc1
    s_branch L_fin
L_redgo:
    s_mov_b64 exec, -1
    s_cmp_ge_u32 s68, 36
    s_cbranch_scc1 L_finb
    s_barrier
    ds_read_b32 v53, v2 offset:8
    s_sleep 24
    s_waitcnt lgkmcnt(0)
L_red:
    s_mov_b32 s62, 0x8000
    s_mov_b64 s[66:67], exec
L_mp23:
    s_cbranch_execz L_sk25
    buffer_load_dwordx4 v[72:75], v54, s[40:43], s48 offen sc1
    buffer_load_dwordx4 v[76:79], v54, s[40:43], s49 offen sc1
    buffer_load_dwordx4 v[80:83], v54, s[40:43], s50 offen sc1
    buffer_load_dwordx4 v[84:87], v54, s[40:43], s51 offen sc1
L_sk25:
    s_waitcnt vmcnt(0)
    v_xor_b32 v60, v53, v73
    v_xor_b32 v61, v53, v75
    v_bitop3_b32 v60, v60, v53, v77 bitop3:0xf6
    v_bitop3_b32 v61, v61, v53, v79 bitop3:0xf6
    v_bitop3_b32 v60, v60, v53, v81 bitop3:0xf6
    v_bitop3_b32 v61, v61, v53, v83 bitop3:0xf6
    v_bitop3_b32 v60, v60, v53, v85 bitop3:0xf6
    v_bitop3_b32 v61, v61, v53, v87 bitop3:0xf6
    v_or_b32 v60, v60, v61
    v_cmpx_ne_u32 vcc, 0, v60
    s_cbranch_vccz L_mpx24
    s_sub_u32 s62, s62, 1
    s_cbranch_scc0 L_mp23
L_mpx24:
    s_mov_b64 exec, s[66:67]
    s_nop 2
    v_dot2_f32_bf16 v64, v72, s70, 0
    v_dot2_f32_bf16 v65, v72, s71, 0
    v_dot2_f32_bf16 v66, v74, s70, 0
    v_dot2_f32_bf16 v67, v74, s71, 0
    v_dot2_f32_bf16 v64, v76, s70, v64
    v_dot2_f32_bf16 v65, v76, s71, v65
    v_dot2_f32_bf16 v66, v78, s70, v66
    v_dot2_f32_bf16 v67, v78, s71, v67
    v_dot2_f32_bf16 v64, v80, s70, v64
    v_dot2_f32_bf16 v65, v80, s71, v65
    v_dot2_f32_bf16 v66, v82, s70, v66
    v_dot2_f32_bf16 v67, v82, s71, v67
    v_dot2_f32_bf16 v64, v84, s70, v64
    v_dot2_f32_bf16 v65, v84, s71, v65
    v_dot2_f32_bf16 v66, v86, s70, v66
    v_dot2_f32_bf16 v67, v86, s71, v67
    s_nop 1
    v_permlane32_swap_b32 v64, v66
    v_permlane32_swap_b32 v65, v67
    v_add_f32 v64, v64, v66
    v_add_f32 v65, v65, v67
    s_nop 1
    v_permlane16_swap_b32 v64, v65
    v_add_f32 v64, v64, v65
    s_nop 1
    v_add_f32_dpp v64, v64, v64 row_ror:8 row_mask:0xf bank_mask:0xf
    s_nop 1
    v_add_f32_dpp v64, v64, v64 row_ror:4 row_mask:0xf bank_mask:0xf
    s_nop 1
    v_add_f32_dpp v64, v64, v64 row_ror:2 row_mask:0xf bank_mask:0xf
    v_mov_b32 v65, v64
    s_nop 1
    v_permlane16_swap_b32 v64, v65
    v_cvt_pk_bf16_f32 v64, v64, v65
    s_cbranch_execz L_dryx
    buffer_store_dword v64, v55, s[44:47], s57 offen
    s_cmp_eq_u32 s2, 0
    s_cbranch_scc0 L_fin
    s_mov_b64 exec, 1
    buffer_store_dword v53, v2, s[40:43], 0 offen sc1
L_fin:
L_end:
    s_endpgm
L_dryx:
    s_branch L_redgo
.section .rodata,"a"
.p2align 6
.amdhsa_kernel concat_heads__sliding_block_cached__gqa_block_cached__decode_kernel
  .amdhsa_next_free_vgpr 168
  .amdhsa_next_free_sgpr 96
  .amdhsa_accum_offset 168
  .amdhsa_group_segment_fixed_size 0
  .amdhsa_kernarg_size 104
  .amdhsa_user_sgpr_count 2
  .amdhsa_user_sgpr_kernarg_segment_ptr 1
  .amdhsa_system_sgpr_workgroup_id_x 1
.end_amdhsa_kernel
```
